```python
import torch

def _softmax(x, axis=-1):
    return torch.softmax(x, dim=axis)
def _gelu(x):
    return torch.nn.functional.gelu(x, approximate="tanh")
def _silu(x):
    return torch.nn.functional.silu(x)
def _sigmoid(x):
    return torch.sigmoid(x)
def _layernorm(x, axis=-1, eps=1e-5):
    m = x.mean(dim=axis, keepdim=True)
    v = x.var(dim=axis, keepdim=True, unbiased=False)
    return (x - m) / torch.sqrt(v + eps)
def _scatter_add(tgt, idx, src, axis=0):
    return tgt.clone().index_add_(axis, idx, src)
def _segment_sum(src, seg, n):
    out = torch.zeros((n,) + src.shape[1:], dtype=src.dtype)
    return out.index_add_(0, seg, src)
def _pad(x, pw):
    flat = tuple(v for pair in reversed(pw) for v in pair)
    return torch.nn.functional.pad(x, flat)

kernel_name = 'sequential_preLN__sliding_block__mixer_channel_mlp__prompt'

def setup_inputs():

    _w = (lambda a: (lambda t: t.to(torch.bfloat16) if t.is_floating_point() else t)(torch.as_tensor(a)))
    def _A_setup():
        B, S, D = 1, 2048, 512
        return {
            "x": _w((lambda *s: torch.randn(*s, dtype=torch.bfloat16) * 0.05)(B, S, D)),
            "wqkv": _w((lambda *s: torch.randn(*s, dtype=torch.bfloat16) * 0.05)(D, 3 * D)),
            "wo": _w((lambda *s: torch.randn(*s, dtype=torch.bfloat16) * 0.05)(D, D)),
        }
    _A_in = _A_setup()

    def _B_setup():
        B, S, D, F = 1, 2048, 512, 1792
        return {
            "x": _w((lambda *s: torch.randn(*s, dtype=torch.bfloat16) * 0.05)(B, S, D)),
            "w1": _w((lambda *s: torch.randn(*s, dtype=torch.bfloat16) * 3.2)(D, F) * (D ** -0.5)),
            "b1": _w((lambda *s: torch.randn(*s, dtype=torch.bfloat16) * 1.6)(F)),
            "w2": _w((lambda *s: torch.randn(*s, dtype=torch.bfloat16) * 0.2)(F, D) * (F ** -0.5)),
            "b2": _w((lambda *s: torch.randn(*s, dtype=torch.bfloat16) * 0.2)(D)),
        }
    _B_in = _B_setup()

    return {
        "A_x": _A_in["x"],
        "A_wqkv": _A_in["wqkv"],
        "A_wo": _A_in["wo"],
        "B_x": _B_in["x"],
        "B_w1": _B_in["w1"],
        "B_b1": _B_in["b1"],
        "B_w2": _B_in["w2"],
        "B_b2": _B_in["b2"],
    }

def reference(A_x, A_wqkv, A_wo, B_x, B_w1, B_b1, B_w2, B_b2):
    def _A_ref(x, wqkv, wo):
        B, S, D = x.shape
        H = 32; Dh = D // H; W = 256
        qkv = (lambda x, *d: x.permute(*d))((x @ wqkv).reshape(B, S, 3, H, Dh), 2, 0, 3, 1, 4)
        q, k, v = qkv[0], qkv[1], qkv[2]
        scores = torch.einsum("bhqd,bhkd->bhqk", q, k) * (Dh ** -0.5)
        idx = torch.arange(S)
        mask = (idx[:, None] - idx[None, :] >= 0) & (idx[:, None] - idx[None, :] < W)
        scores = torch.where(mask[None, None], scores, -1e9)
        p = _softmax(scores, axis=-1)
        o = torch.einsum("bhqk,bhkd->bhqd", p, v)
        return (lambda x, *d: x.permute(*d))(o, 0, 2, 1, 3).reshape(B, S, D) @ wo

    def _B_ref(x, w1, b1, w2, b2):
        y = _layernorm(x, axis=-1)
        h = _gelu(torch.einsum("bsd,df->bsf", y, w1) + b1)
        return torch.einsum("bsf,fd->bsd", h, w2) + b2

    x = A_x
    h = x + _A_ref(_layernorm(x, axis=-1), A_wqkv, A_wo)
    h2 = h + _B_ref(_layernorm(h, axis=-1), B_w1, B_b1, B_w2, B_b2)
    return h2
```

```asm
; @launch grid=(256,1,1) block=(256,1,1) lds=163840
.amdgcn_target "amdgcn-amd-amdhsa--gfx950"
.text
.globl sequential_preLN__sliding_block__mixer_channel_mlp__prompt_kernel
.p2align 8
.type sequential_preLN__sliding_block__mixer_channel_mlp__prompt_kernel,@function
sequential_preLN__sliding_block__mixer_channel_mlp__prompt_kernel:
    s_cmp_ge_u32 s2, 0x100
    s_cbranch_scc1 L_end
    s_load_dwordx16 s[44:59], s[0:1], 0
    s_load_dwordx4 s[60:63], s[0:1], 64
    s_load_dwordx2 s[4:5], s[0:1], 80
    s_getpc_b64 s[92:93]
L_pc:
    v_and_b32 v17, 15, v0
    v_lshrrev_b32 v18, 6, v0
    v_lshl_add_u32 v17, v18, 4, v17
    s_lshr_b32 s97, s2, 3
    s_lshl_b32 s96, s97, 4
    v_and_b32 v19, 3, v0
    v_lshl_add_u32 v19, v18, 2, v19
    v_add_u32 v19, s96, v19
    v_add_u32 v19, 64, v19
    v_and_b32 v18, 16, v0
    v_cmp_eq_u32 vcc, 0, v18
    s_sub_u32 s92, s92, L_pc-sequential_preLN__sliding_block__mixer_channel_mlp__prompt_kernel
    s_subb_u32 s93, s93, 0
    v_cndmask_b32 v17, v19, v17, vcc
    v_lshlrev_b32 v17, 7, v17
    v_min_u32 v17, L_code_end-sequential_preLN__sliding_block__mixer_channel_mlp__prompt_kernel-4, v17
    s_mov_b64 exec, 0xfffff
    global_load_dword v242, v17, s[92:93]
    s_mov_b64 exec, -1
    v_lshrrev_b32 v17, 6, v0
    v_and_b32 v0, 63, v0
    v_readfirstlane_b32 s3, v17
    v_lshlrev_b32 v1, 4, v0
    v_lshrrev_b32 v17, 3, v0
    v_lshrrev_b32 v18, 4, v0
    v_and_b32 v19, 7, v0
    v_xor_b32 v192, v19, v18
    v_lshlrev_b32 v192, 4, v192
    v_lshl_add_u32 v192, v17, 10, v192
    v_and_b32 v18, 1, v18
    v_lshlrev_b32 v18, 2, v18
    v_xor_b32 v19, v19, v18
    v_lshlrev_b32 v19, 4, v19
    v_mul_u32_u24 v194, 3072, v17
    v_add_u32 v194, v194, v19
    v_lshl_add_u32 v20, v17, 10, v19
    s_lshr_b32 s97, s2, 3
    s_and_b32 s96, s2, 7
    s_lshl_b32 s96, s96, 1
    s_lshr_b32 s98, s97, 4
    s_add_u32 s96, s96, s98
    s_and_b32 s98, s97, 15
    s_lshr_b32 s99, s98, 3
    s_lshl_b32 s100, s96, 1
    s_add_u32 s99, s99, s100
    s_and_b32 s100, s98, 7
    s_and_b32 s64, s99, 3
    s_lshl_b32 s64, s64, 1
    s_cmp_eq_u32 s100, 3
    s_cselect_b32 s101, s64, 0
    s_add_u32 s101, s101, s100
    s_lshl_b32 s64, s99, 16
    s_lshl_b32 s65, s3, 14
    s_add_u32 s64, s64, s65
    v_add_u32 v192, s64, v192
    v_xor_b32 v193, 64, v192
    v_add_u32 v193, 7168, v193
    s_mul_i32 s64, s3, 49152
    s_lshl_b32 s65, s100, 7
    s_add_u32 s64, s64, s65
    v_add_u32 v194, s64, v194
    v_add_u32 v195, 23552, v194
    v_add_u32 v20, s65, v20
    s_add_u32 s2, s101, 0
    s_and_b32 s2, s2, 7
    s_lshl_b32 s72, s2, 7
    s_mul_i32 s64, s2, 196608
    s_add_u32 s2, s101, 1
    s_and_b32 s2, s2, 7
    s_lshl_b32 s73, s2, 7
    s_mul_i32 s65, s2, 196608
    s_add_u32 s2, s101, 2
    s_and_b32 s2, s2, 7
    s_lshl_b32 s74, s2, 7
    s_mul_i32 s66, s2, 196608
    s_add_u32 s2, s101, 3
    s_and_b32 s2, s2, 7
    s_lshl_b32 s75, s2, 7
    s_mul_i32 s67, s2, 196608
    s_add_u32 s2, s101, 4
    s_and_b32 s2, s2, 7
    s_lshl_b32 s76, s2, 7
    s_mul_i32 s68, s2, 196608
    s_add_u32 s2, s101, 5
    s_and_b32 s2, s2, 7
    s_lshl_b32 s77, s2, 7
    s_mul_i32 s69, s2, 196608
    s_add_u32 s2, s101, 6
    s_and_b32 s2, s2, 7
    s_lshl_b32 s78, s2, 7
    s_mul_i32 s70, s2, 196608
    s_add_u32 s2, s101, 7
    s_and_b32 s2, s2, 7
    s_lshl_b32 s79, s2, 7
    s_mul_i32 s71, s2, 196608
    s_waitcnt lgkmcnt(0)
    s_mov_b32 s0, s3
    s_mov_b32 s8, s44
    s_and_b32 s9, s45, 0xffff
    s_mov_b32 s10, 0x200000
    s_mov_b32 s11, 0x20000
    s_mov_b32 s12, s46
    s_and_b32 s13, s47, 0xffff
    s_mov_b32 s14, 0x180000
    s_mov_b32 s15, 0x20000
    s_lshl_b32 s1, s0, 11
    s_add_u32 m0, s1, 0
    s_nop 0
    buffer_load_dwordx4 v192, s[8:11], s72 offen lds
    buffer_load_dwordx4 v193, s[8:11], s72 offen offset:1024 lds
    s_add_u32 m0, s1, 65536
    s_add_u32 s3, s64, 1024
    buffer_load_dwordx4 v194, s[12:15], s3 offen lds
    buffer_load_dwordx4 v195, s[12:15], s3 offen offset:1024 lds
    s_add_u32 m0, s1, 73728
    s_add_u32 s3, s64, 2048
    buffer_load_dwordx4 v194, s[12:15], s3 offen lds
    buffer_load_dwordx4 v195, s[12:15], s3 offen offset:1024 lds
    s_lshl_b32 s90, s96, 4
    s_add_u32 s90, s90, s98
    s_lshl_b32 s90, s90, 2
    s_add_u32 s90, s90, s0
    s_mul_i32 s90, s90, 1536
    v_lshlrev_b32 v17, 7, v0
    s_mov_b64 exec, 0xfff
    buffer_load_dword v246, v17, s[12:15], s90 offen
    s_mov_b64 exec, -1
    s_mov_b32 s28, s4
    s_and_b32 s29, s5, 0xffff
    s_mov_b32 s30, 0x1000000
    s_mov_b32 s31, 0x20000
    s_add_u32 s4, s99, 1
    v_add_u32 v18, s4, v0
    s_add_u32 m0, s1, 8192
    s_nop 0
    buffer_load_dwordx4 v192, s[8:11], s73 offen lds
    v_lshrrev_b32 v18, 1, v18
    v_min_u32 v18, 15, v18
    v_mov_b32 v19, s96
    v_cmp_gt_u32 vcc, 4, v0
    s_mov_b32 s16, s48
    s_and_b32 s17, s49, 0xffff
    buffer_load_dwordx4 v193, s[8:11], s73 offen offset:1024 lds
    s_mov_b32 s18, 0x80000
    s_mov_b32 s19, 0x20000
    v_cndmask_b32 v18, v19, v18, vcc
    v_lshlrev_b32 v18, 3, v18
    buffer_load_dwordx2 v[14:15], v18, s[28:31], 0 offen sc1
    s_mov_b32 s20, s52
    s_add_u32 m0, s1, 81920
    s_add_u32 s3, s65, 1024
    buffer_load_dwordx4 v194, s[12:15], s3 offen lds
    s_and_b32 s21, s53, 0xffff
    s_mov_b32 s22, 0x1c0000
    s_mov_b32 s23, 0x20000
    s_mov_b32 s36, s54
    s_and_b32 s37, s55, 0xffff
    s_mov_b32 s38, 0xe00
    buffer_load_dwordx4 v195, s[12:15], s3 offen offset:1024 lds
    s_mov_b32 s39, 0x20000
    s_mov_b32 s24, s56
    s_and_b32 s25, s57, 0xffff
    s_mov_b32 s26, 0x1c0000
    s_mov_b32 s27, 0x20000
    s_mov_b32 s40, s58
    s_add_u32 m0, s1, 90112
    s_add_u32 s3, s65, 2048
    buffer_load_dwordx4 v194, s[12:15], s3 offen lds
    s_and_b32 s41, s59, 0xffff
    s_mov_b32 s42, 0x400
    s_mov_b32 s43, 0x20000
    s_mov_b32 s32, s60
    s_and_b32 s33, s61, 0xffff
    s_mov_b32 s34, 0x200000
    buffer_load_dwordx4 v195, s[12:15], s3 offen offset:1024 lds
    s_mov_b32 s35, 0x20000
    s_mov_b64 s[6:7], s[62:63]
    s_mov_b32 s44, s0
    s_mov_b32 s45, s96
    s_mov_b32 s46, s98
    s_mov_b32 s47, s99
    s_mov_b32 s48, s100
    s_mov_b32 s60, s1
    s_lshr_b32 s61, s44, 1
    s_and_b32 s62, s44, 1
    s_mov_b32 s63, 0x3f803f80
    s_sub_u32 s0, s100, s101
    s_and_b32 s0, s0, 7
    s_lshl_b32 s0, s0, 13
    s_xor_b32 s57, s61, s62
    v_and_b32 v17, 31, v0
    v_lshrrev_b32 v18, 5, v0
    v_bfe_u32 v32, v0, 1, 3
    v_xor_b32 v32, v32, v18
    v_lshlrev_b32 v32, 4, v32
    v_lshl_add_u32 v32, v17, 7, v32
    s_lshl_b32 s55, s62, 12
    v_add_u32 v32, s55, v32
    s_lshl_b32 s55, s57, 5
    v_xor_b32 v32, s55, v32
    v_xor_b32 v196, 0, v32
    v_xor_b32 v197, 32, v32
    v_xor_b32 v198, 64, v32
    v_xor_b32 v199, 96, v32
    v_bfe_u32 v34, v0, 2, 2
    v_lshlrev_b32 v33, 7, v34
    v_lshrrev_b32 v34, 1, v34
    v_lshl_add_u32 v33, v34, 6, v33
    v_bfe_u32 v34, v0, 4, 1
    v_lshl_add_u32 v33, v34, 5, v33
    v_and_b32 v34, 3, v0
    v_lshl_add_u32 v33, v34, 3, v33
    v_lshrrev_b32 v34, 5, v0
    v_lshl_add_u32 v33, v34, 10, v33
    s_lshl_b32 s55, s61, 6
    v_xor_b32 v33, s55, v33
    v_add_u32 v33, 65536, v33
    s_lshl_b32 s55, s57, 11
    v_add_u32 v200, s55, v33
    v_subrev_u32 v201, s55, v33
    v_add_u32 v202, 0x10000, v200
    v_add_u32 v203, 0x10000, v201
    s_mov_b32 s96, -1
    s_mov_b32 s97, 0
    s_mov_b32 s98, 0xffff
    s_mov_b32 s99, 0xffff
    s_getreg_b32 s49, hwreg(HW_REG_XCC_ID, 0, 4)
    v_lshrrev_b32 v34, 2, v0
    v_xor_b32 v34, v34, v0
    v_bfe_u32 v34, v34, 2, 1
    v_and_or_b32 v34, v0, 3, v34
    v_cmp_eq_u32 vcc, 0, v34
    v_mov_b32 v34, s63
    s_nop 0
    v_cndmask_b32 v248, 0, v34, vcc
    v_cndmask_b32 v249, 0, v34, vcc
    v_cndmask_b32 v250, 0, v34, vcc
    v_cndmask_b32 v251, 0, v34, vcc
    s_mov_b32 s80, 0x22222222
    s_mov_b32 s81, 0x22222222
    s_mov_b32 s82, 0x44444444
    s_mov_b32 s83, 0x44444444
    s_mov_b32 s84, 0x88888888
    s_mov_b32 s85, 0x88888888
    v_mov_b32 v162, 0
    v_mov_b32 v163, 0
    v_mov_b32 v166, 0
    v_mov_b32 v167, 0
    v_mov_b32 v170, 0
    v_mov_b32 v171, 0
    v_mov_b32 v173, 0
    v_mov_b32 v174, 0
    v_mov_b32 v175, 0
    v_mov_b32 v177, 0
    v_mov_b32 v178, 0
    v_mov_b32 v179, 0
    v_mov_b32 v176, s63
    v_lshlrev_b32 v18, 2, v18
    v_sub_u32 v17, v17, v18
    v_mov_b32 v18, 0xffff
    v_mov_b32 v19, 0xffff0000
    v_cmp_le_i32 vcc, 0, v17
    v_cmp_le_i32 s[100:101], 1, v17
    s_nop 0
    v_cndmask_b32 v32, 0, v18, vcc
    v_cndmask_b32 v22, 0, v19, s[100:101]
    v_or_b32 v22, v22, v32
    v_cmp_le_i32 vcc, 2, v17
    v_cmp_le_i32 s[100:101], 3, v17
    s_nop 0
    v_cndmask_b32 v32, 0, v18, vcc
    v_cndmask_b32 v23, 0, v19, s[100:101]
    v_or_b32 v23, v23, v32
    v_cmp_le_i32 vcc, 8, v17
    v_cmp_le_i32 s[100:101], 9, v17
    s_nop 0
    v_cndmask_b32 v32, 0, v18, vcc
    v_cndmask_b32 v24, 0, v19, s[100:101]
    v_or_b32 v24, v24, v32
    v_cmp_le_i32 vcc, 10, v17
    v_cmp_le_i32 s[100:101], 11, v17
    s_nop 0
    v_cndmask_b32 v32, 0, v18, vcc
    v_cndmask_b32 v25, 0, v19, s[100:101]
    v_or_b32 v25, v25, v32
    v_cmp_le_i32 vcc, 16, v17
    v_cmp_le_i32 s[100:101], 17, v17
    s_nop 0
    v_cndmask_b32 v32, 0, v18, vcc
    v_cndmask_b32 v26, 0, v19, s[100:101]
    v_or_b32 v26, v26, v32
    v_cmp_le_i32 vcc, 18, v17
    v_cmp_le_i32 s[100:101], 19, v17
    s_nop 0
    v_cndmask_b32 v32, 0, v18, vcc
    v_cndmask_b32 v27, 0, v19, s[100:101]
    v_or_b32 v27, v27, v32
    v_cmp_le_i32 vcc, 24, v17
    v_cmp_le_i32 s[100:101], 25, v17
    s_nop 0
    v_cndmask_b32 v32, 0, v18, vcc
    v_cndmask_b32 v28, 0, v19, s[100:101]
    v_or_b32 v28, v28, v32
    v_cmp_le_i32 vcc, 26, v17
    v_cmp_le_i32 s[100:101], 27, v17
    s_nop 0
    v_cndmask_b32 v32, 0, v18, vcc
    v_cndmask_b32 v29, 0, v19, s[100:101]
    v_or_b32 v29, v29, v32
    v_mov_b32 v32, 0x3afe3f80
    v_cndmask_b32 v172, 0, v32, s[96:97]
    s_nop 0
    s_nop 0
    v_mfma_f32_32x32x16_bf16 a[40:55], v[172:175], v[176:179], 0
    v_mfma_f32_32x32x16_bf16 a[56:71], v[172:175], v[176:179], 0
    v_mfma_f32_32x32x16_bf16 a[72:87], v[172:175], v[176:179], 0
    v_mfma_f32_32x32x16_bf16 a[88:103], v[172:175], v[176:179], 0
    v_mfma_f32_32x32x16_bf16 a[104:119], v[172:175], v[176:179], 0
    s_lshl_b32 s55, s45, 4
    s_add_u32 s55, s55, s46
    s_lshl_b32 s86, s55, 2
    s_add_u32 s86, s86, s44
    s_mul_i32 s86, s86, 1792
    s_and_b32 s87, s55, 3
    s_mul_i32 s87, s87, 458752
    s_andn2_b32 s55, s55, 3
    s_add_u32 s55, s55, s44
    s_mul_i32 s55, s55, 640
    s_add_u32 s87, s87, s55
    v_lshlrev_b32 v244, 7, v0
    s_lshl_b32 s59, s44, 13
    v_bfe_u32 v19, v0, 2, 2
    v_lshlrev_b32 v30, 7, v19
    v_lshrrev_b32 v19, 1, v19
    v_lshl_add_u32 v30, v19, 6, v30
    v_bfe_u32 v19, v0, 4, 1
    v_lshl_add_u32 v30, v19, 5, v30
    v_and_b32 v19, 3, v0
    v_lshl_add_u32 v30, v19, 3, v30
    v_lshrrev_b32 v19, 5, v0
    v_lshl_add_u32 v30, v19, 9, v30
    s_lshl_b32 s55, s61, 6
    s_lshl_b32 s56, s62, 5
    s_or_b32 s55, s55, s56
    v_xor_b32 v30, s55, v30
    s_add_u32 s55, s59, 131072
    v_add_u32 v30, s55, v30
    v_xor_b32 v31, 64, v30
    v_lshrrev_b32 v17, 4, v0
    v_lshlrev_b32 v18, 2, v17
    v_and_b32 v19, 15, v0
    v_xor_b32 v18, v18, v19
    v_lshlrev_b32 v18, 4, v18
    v_mul_u32_u24 v21, 3584, v17
    v_add_u32 v21, v21, v18
    s_mul_i32 s55, s44, 57344
    s_cmp_gt_u32 s46, 3
    s_subb_u32 s56, s46, 0
    s_cmp_gt_u32 s46, 11
    s_subb_u32 s56, s56, 0
    s_lshl_b32 s56, s56, 8
    s_add_u32 s55, s55, s56
    v_add_u32 v21, s55, v21
    v_add_u32 v189, 13312, v21
    v_add_u32 v190, 26624, v21
    v_add_u32 v191, 39936, v21
    s_cmp_eq_u32 s48, 3
    s_cselect_b32 s56, 0, -1
    v_and_b32 v21, s56, v21
    v_and_b32 v189, s56, v189
    v_and_b32 v190, s56, v190
    v_and_b32 v191, s56, v191
    v_mov_b32 v188, 0xff800000
    v_mov_b32 v184, 0xff800000
    v_mov_b32 v185, 0xff800000
    v_mov_b32 v186, 0xff800000
    v_mov_b32 v187, 0xff800000
    v_bfe_u32 v150, v0, 1, 2
    v_lshlrev_b32 v150, 2, v150
    v_and_b32 v151, 1, v0
    v_add_u32 v150, v151, v150
    v_lshl_add_u32 v150, s61, 1, v150
    v_lshlrev_b32 v150, 3, v150
    s_lshl_b32 s58, s47, 3
    s_add_u32 s58, s58, s48
    s_lshl_b32 s58, s58, 7
    s_add_u32 s58, s58, 0x2000
    v_add_u32 v236, 7168, v20
    v_add_u32 v237, 14336, v20
    v_add_u32 v238, 21504, v20
    s_lshl_b32 s2, s44, 17
    s_lshl_b32 s1, s44, 12
    s_add_u32 s55, s47, 1
    v_add_u32 v148, s55, v0
    v_lshlrev_b32 v148, 3, v148
    v_add_u32 v148, s48, v148
    v_lshlrev_b32 v148, 2, v148
    v_add_u32 v148, v148, v0
    v_lshl_add_u32 v148, v148, 2, s44
    v_lshlrev_b32 v148, 3, v148
    v_and_b32 v149, 15, v0
    v_lshlrev_b32 v149, 3, v149
    v_and_b32 v153, 31, v0
    v_bfe_u32 v154, v0, 1, 3
    s_lshl_b32 s55, s44, 1
    v_xor_b32 v154, s55, v154
    v_lshlrev_b32 v154, 4, v154
    v_lshl_add_u32 v154, v153, 7, v154
    v_lshrrev_b32 v153, 5, v0
    v_lshl_add_u32 v154, v153, 3, v154
    v_add_u32 v154, s0, v154
    v_xor_b32 v155, 16, v154
    s_waitcnt vmcnt(8)
    s_waitcnt vmcnt(4)
    v_add_u32 v15, 0x9e3779b9, v15
    v_readlane_b32 s53, v14, 4
    v_add_u32 v14, 1, v14
    v_lshlrev_b32 v14, 4, v14
    v_readlane_b32 s51, v15, 4
    v_readlane_b32 s50, v14, 4
    s_waitcnt lgkmcnt(0)
    s_barrier
    ds_read_b128 v[96:99], v196 offset:0
    ds_read_b64_tr_b16 v[112:113], v200 offset:0
    ds_read_b64_tr_b16 v[114:115], v200 offset:512
    ds_read_b64_tr_b16 v[128:129], v200 offset:8192
    ds_read_b64_tr_b16 v[130:131], v200 offset:8704
    ds_read_b128 v[104:107], v198 offset:0
    ds_read_b64_tr_b16 v[120:121], v200 offset:4096
    ds_read_b64_tr_b16 v[122:123], v200 offset:4608
    ds_read_b64_tr_b16 v[136:137], v200 offset:12288
    ds_read_b64_tr_b16 v[138:139], v200 offset:12800
    s_add_u32 m0, s60, 16384
    s_nop 0
    buffer_load_dwordx4 v192, s[8:11], s74 offen lds
    buffer_load_dwordx4 v193, s[8:11], s74 offen offset:1024 lds
    s_add_u32 m0, s60, 98304
    s_add_u32 s3, s66, 1024
    buffer_load_dwordx4 v194, s[12:15], s3 offen lds
    buffer_load_dwordx4 v195, s[12:15], s3 offen offset:1024 lds
    s_cmp_lg_u32 s44, 0
    s_cbranch_scc1 L_w0_1
    s_add_u32 s54, s50, s49
    v_mov_b32 v18, s54
    v_mov_b32 v19, s51
    s_lshl_b32 s55, s45, 7
    s_lshl_b32 s56, s46, 3
    s_add_u32 s55, s55, s56
    v_mov_b32 v17, 0
    s_mov_b64 exec, 1
    buffer_store_dwordx2 v[18:19], v17, s[28:31], s55 offen offset:1024 sc1
    s_mov_b64 exec, -1
L_w0_1:
    s_add_u32 m0, s60, 106496
    s_add_u32 s3, s66, 2048
    buffer_load_dwordx4 v194, s[12:15], s3 offen lds
    buffer_load_dwordx4 v195, s[12:15], s3 offen offset:1024 lds
    s_add_u32 m0, s60, 24576
    s_nop 0
    buffer_load_dwordx4 v192, s[8:11], s75 offen lds
    s_waitcnt lgkmcnt(7)
    v_mfma_f32_32x32x16_bf16 v[32:47], v[112:115], v[96:99], 0
    ds_read_b128 v[100:103], v197 offset:0
    ds_read_b64_tr_b16 v[116:117], v201 offset:2048
    ds_read_b64_tr_b16 v[118:119], v201 offset:2560
    ds_read_b64_tr_b16 v[132:133], v201 offset:10240
    ds_read_b64_tr_b16 v[134:135], v201 offset:10752
    s_waitcnt lgkmcnt(10)
    v_mfma_f32_32x32x16_bf16 v[48:63], v[96:99], v[128:131], 0
    ds_read_b128 v[108:111], v199 offset:0
    ds_read_b64_tr_b16 v[124:125], v201 offset:6144
    ds_read_b64_tr_b16 v[126:127], v201 offset:6656
    ds_read_b64_tr_b16 v[140:141], v201 offset:14336
    ds_read_b64_tr_b16 v[142:143], v201 offset:14848
    s_waitcnt lgkmcnt(12)
    v_mfma_f32_32x32x16_bf16 v[32:47], v[120:123], v[104:107], v[32:47]
    buffer_load_dwordx4 v193, s[8:11], s75 offen offset:1024 lds
    s_waitcnt lgkmcnt(10)
    v_mfma_f32_32x32x16_bf16 v[48:63], v[104:107], v[136:139], v[48:63]
    s_add_u32 m0, s60, 114688
    s_add_u32 s3, s67, 1024
    buffer_load_dwordx4 v194, s[12:15], s3 offen lds
    s_waitcnt lgkmcnt(7)
    v_mfma_f32_32x32x16_bf16 v[32:47], v[116:119], v[100:103], v[32:47]
    buffer_load_dwordx4 v195, s[12:15], s3 offen offset:1024 lds
    s_waitcnt lgkmcnt(5)
    v_mfma_f32_32x32x16_bf16 v[48:63], v[100:103], v[132:135], v[48:63]
    s_add_u32 m0, s60, 122880
    s_add_u32 s3, s67, 2048
    buffer_load_dwordx4 v194, s[12:15], s3 offen lds
    buffer_load_dwordx4 v195, s[12:15], s3 offen offset:1024 lds
    s_waitcnt vmcnt(12)
    s_waitcnt lgkmcnt(0)
    s_barrier
    v_mfma_f32_32x32x16_bf16 v[32:47], v[124:127], v[108:111], v[32:47]
    ds_read_b128 v[96:99], v196 offset:8192
    ds_read_b64_tr_b16 v[112:113], v200 offset:16384
    ds_read_b64_tr_b16 v[114:115], v200 offset:16896
    ds_read_b64_tr_b16 v[128:129], v200 offset:24576
    ds_read_b64_tr_b16 v[130:131], v200 offset:25088
    v_mfma_f32_32x32x16_bf16 v[48:63], v[108:111], v[140:143], v[48:63]
    ds_read_b128 v[104:107], v198 offset:8192
    ds_read_b64_tr_b16 v[120:121], v200 offset:20480
    ds_read_b64_tr_b16 v[122:123], v200 offset:20992
    ds_read_b64_tr_b16 v[136:137], v200 offset:28672
    ds_read_b64_tr_b16 v[138:139], v200 offset:29184
    s_add_u32 m0, s60, 32768
    s_nop 0
    buffer_load_dwordx4 v192, s[8:11], s76 offen lds
    v_mfma_f32_16x16x32_bf16 v[64:67], v[248:251], v[100:103], 0
    v_mfma_f32_4x4x4_16b_bf16 v[76:79], v[100:101], v[100:101], 0
    v_mfma_f32_16x16x32_bf16 v[68:71], v[248:251], v[116:119], 0
    buffer_load_dwordx4 v193, s[8:11], s76 offen offset:1024 lds
    v_mfma_f32_4x4x4_16b_bf16 v[80:83], v[102:103], v[102:103], 0
    v_mfma_f32_16x16x32_bf16 v[72:75], v[248:251], v[132:135], 0
    v_mfma_f32_16x16x32_bf16 v[64:67], v[248:251], v[108:111], v[64:67]
    v_mfma_f32_4x4x4_16b_bf16 v[76:79], v[108:109], v[108:109], v[76:79]
    v_mfma_f32_16x16x32_bf16 v[68:71], v[248:251], v[124:127], v[68:71]
    s_add_u32 m0, s60, 131072
    s_add_u32 s3, s68, 1024
    buffer_load_dwordx4 v194, s[12:15], s3 offen lds
    v_mfma_f32_4x4x4_16b_bf16 v[80:83], v[110:111], v[110:111], v[80:83]
    v_mfma_f32_16x16x32_bf16 v[72:75], v[248:251], v[140:143], v[72:75]
    s_waitcnt lgkmcnt(7)
    v_mfma_f32_32x32x16_bf16 v[32:47], v[112:115], v[96:99], v[32:47]
    ds_read_b128 v[100:103], v197 offset:8192
    ds_read_b64_tr_b16 v[116:117], v201 offset:18432
    ds_read_b64_tr_b16 v[118:119], v201 offset:18944
    ds_read_b64_tr_b16 v[132:133], v201 offset:26624
    ds_read_b64_tr_b16 v[134:135], v201 offset:27136
    s_waitcnt lgkmcnt(10)
    v_mfma_f32_32x32x16_bf16 v[48:63], v[96:99], v[128:131], v[48:63]
    ds_read_b128 v[108:111], v199 offset:8192
    ds_read_b64_tr_b16 v[124:125], v201 offset:22528
    ds_read_b64_tr_b16 v[126:127], v201 offset:23040
    ds_read_b64_tr_b16 v[140:141], v201 offset:30720
    ds_read_b64_tr_b16 v[142:143], v201 offset:31232
    s_waitcnt lgkmcnt(12)
    v_mfma_f32_32x32x16_bf16 v[32:47], v[120:123], v[104:107], v[32:47]
    buffer_load_dwordx4 v195, s[12:15], s3 offen offset:1024 lds
    s_waitcnt lgkmcnt(10)
    v_mfma_f32_32x32x16_bf16 v[48:63], v[104:107], v[136:139], v[48:63]
    s_waitcnt lgkmcnt(7)
    v_mfma_f32_32x32x16_bf16 v[32:47], v[116:119], v[100:103], v[32:47]
    s_add_u32 m0, s60, 139264
    s_add_u32 s3, s68, 2048
    buffer_load_dwordx4 v194, s[12:15], s3 offen lds
    s_waitcnt lgkmcnt(5)
    v_mfma_f32_32x32x16_bf16 v[48:63], v[100:103], v[132:135], v[48:63]
    buffer_load_dwordx4 v195, s[12:15], s3 offen offset:1024 lds
    s_waitcnt vmcnt(12)
    s_waitcnt lgkmcnt(0)
    s_barrier
    v_mfma_f32_32x32x16_bf16 v[32:47], v[124:127], v[108:111], v[32:47]
    ds_read_b128 v[96:99], v196 offset:16384
    ds_read_b64_tr_b16 v[112:113], v200 offset:32768
    ds_read_b64_tr_b16 v[114:115], v200 offset:33280
    ds_read_b64_tr_b16 v[128:129], v200 offset:40960
    ds_read_b64_tr_b16 v[130:131], v200 offset:41472
    v_mfma_f32_32x32x16_bf16 v[48:63], v[108:111], v[140:143], v[48:63]
    ds_read_b128 v[104:107], v198 offset:16384
    ds_read_b64_tr_b16 v[120:121], v200 offset:36864
    ds_read_b64_tr_b16 v[122:123], v200 offset:37376
    ds_read_b64_tr_b16 v[136:137], v200 offset:45056
    ds_read_b64_tr_b16 v[138:139], v200 offset:45568
    s_add_u32 m0, s60, 40960
    s_nop 0
    buffer_load_dwordx4 v192, s[8:11], s77 offen lds
    v_mfma_f32_16x16x32_bf16 v[64:67], v[248:251], v[100:103], v[64:67]
    v_mfma_f32_4x4x4_16b_bf16 v[76:79], v[100:101], v[100:101], v[76:79]
    v_mfma_f32_16x16x32_bf16 v[68:71], v[248:251], v[116:119], v[68:71]
    buffer_load_dwordx4 v193, s[8:11], s77 offen offset:1024 lds
    v_mfma_f32_4x4x4_16b_bf16 v[80:83], v[102:103], v[102:103], v[80:83]
    v_mfma_f32_16x16x32_bf16 v[72:75], v[248:251], v[132:135], v[72:75]
    v_mfma_f32_16x16x32_bf16 v[64:67], v[248:251], v[108:111], v[64:67]
    v_mfma_f32_4x4x4_16b_bf16 v[76:79], v[108:109], v[108:109], v[76:79]
    v_mfma_f32_16x16x32_bf16 v[68:71], v[248:251], v[124:127], v[68:71]
    s_add_u32 m0, s60, 65536
    s_add_u32 s3, s69, 1024
    buffer_load_dwordx4 v194, s[12:15], s3 offen lds
    v_mfma_f32_4x4x4_16b_bf16 v[80:83], v[110:111], v[110:111], v[80:83]
    v_mfma_f32_16x16x32_bf16 v[72:75], v[248:251], v[140:143], v[72:75]
    s_waitcnt lgkmcnt(7)
    v_mfma_f32_32x32x16_bf16 v[32:47], v[112:115], v[96:99], v[32:47]
    ds_read_b128 v[100:103], v197 offset:16384
    ds_read_b64_tr_b16 v[116:117], v201 offset:34816
    ds_read_b64_tr_b16 v[118:119], v201 offset:35328
    ds_read_b64_tr_b16 v[132:133], v201 offset:43008
    ds_read_b64_tr_b16 v[134:135], v201 offset:43520
    s_waitcnt lgkmcnt(10)
    v_mfma_f32_32x32x16_bf16 v[48:63], v[96:99], v[128:131], v[48:63]
    ds_read_b128 v[108:111], v199 offset:16384
    ds_read_b64_tr_b16 v[124:125], v201 offset:38912
    ds_read_b64_tr_b16 v[126:127], v201 offset:39424
    ds_read_b64_tr_b16 v[140:141], v201 offset:47104
    ds_read_b64_tr_b16 v[142:143], v201 offset:47616
    s_waitcnt lgkmcnt(12)
    v_mfma_f32_32x32x16_bf16 v[32:47], v[120:123], v[104:107], v[32:47]
    buffer_load_dwordx4 v195, s[12:15], s3 offen offset:1024 lds
    s_waitcnt lgkmcnt(10)
    v_mfma_f32_32x32x16_bf16 v[48:63], v[104:107], v[136:139], v[48:63]
    s_waitcnt lgkmcnt(7)
    v_mfma_f32_32x32x16_bf16 v[32:47], v[116:119], v[100:103], v[32:47]
    s_add_u32 m0, s60, 73728
    s_add_u32 s3, s69, 2048
    buffer_load_dwordx4 v194, s[12:15], s3 offen lds
    s_waitcnt lgkmcnt(5)
    v_mfma_f32_32x32x16_bf16 v[48:63], v[100:103], v[132:135], v[48:63]
    buffer_load_dwordx4 v195, s[12:15], s3 offen offset:1024 lds
    s_waitcnt vmcnt(12)
    s_waitcnt lgkmcnt(0)
    s_barrier
    v_mfma_f32_32x32x16_bf16 v[32:47], v[124:127], v[108:111], v[32:47]
    ds_read_b128 v[96:99], v196 offset:24576
    ds_read_b64_tr_b16 v[112:113], v200 offset:49152
    ds_read_b64_tr_b16 v[114:115], v200 offset:49664
    ds_read_b64_tr_b16 v[128:129], v200 offset:57344
    ds_read_b64_tr_b16 v[130:131], v200 offset:57856
    v_mfma_f32_32x32x16_bf16 v[48:63], v[108:111], v[140:143], v[48:63]
    ds_read_b128 v[104:107], v198 offset:24576
    ds_read_b64_tr_b16 v[120:121], v200 offset:53248
    ds_read_b64_tr_b16 v[122:123], v200 offset:53760
    ds_read_b64_tr_b16 v[136:137], v200 offset:61440
    ds_read_b64_tr_b16 v[138:139], v200 offset:61952
    s_add_u32 m0, s60, 49152
    s_nop 0
    buffer_load_dwordx4 v192, s[8:11], s78 offen lds
    v_mfma_f32_16x16x32_bf16 v[64:67], v[248:251], v[100:103], v[64:67]
    v_mfma_f32_4x4x4_16b_bf16 v[76:79], v[100:101], v[100:101], v[76:79]
    v_mfma_f32_16x16x32_bf16 v[68:71], v[248:251], v[116:119], v[68:71]
    buffer_load_dwordx4 v193, s[8:11], s78 offen offset:1024 lds
    v_mfma_f32_4x4x4_16b_bf16 v[80:83], v[102:103], v[102:103], v[80:83]
    v_mfma_f32_16x16x32_bf16 v[72:75], v[248:251], v[132:135], v[72:75]
    v_mfma_f32_16x16x32_bf16 v[64:67], v[248:251], v[108:111], v[64:67]
    v_mfma_f32_4x4x4_16b_bf16 v[76:79], v[108:109], v[108:109], v[76:79]
    v_mfma_f32_16x16x32_bf16 v[68:71], v[248:251], v[124:127], v[68:71]
    s_add_u32 m0, s60, 81920
    s_add_u32 s3, s70, 1024
    buffer_load_dwordx4 v194, s[12:15], s3 offen lds
    v_mfma_f32_4x4x4_16b_bf16 v[80:83], v[110:111], v[110:111], v[80:83]
    v_mfma_f32_16x16x32_bf16 v[72:75], v[248:251], v[140:143], v[72:75]
    s_waitcnt lgkmcnt(7)
    v_mfma_f32_32x32x16_bf16 v[32:47], v[112:115], v[96:99], v[32:47]
    ds_read_b128 v[100:103], v197 offset:24576
    ds_read_b64_tr_b16 v[116:117], v201 offset:51200
    ds_read_b64_tr_b16 v[118:119], v201 offset:51712
    ds_read_b64_tr_b16 v[132:133], v201 offset:59392
    ds_read_b64_tr_b16 v[134:135], v201 offset:59904
    s_waitcnt lgkmcnt(10)
    v_mfma_f32_32x32x16_bf16 v[48:63], v[96:99], v[128:131], v[48:63]
    ds_read_b128 v[108:111], v199 offset:24576
    ds_read_b64_tr_b16 v[124:125], v201 offset:55296
    ds_read_b64_tr_b16 v[126:127], v201 offset:55808
    ds_read_b64_tr_b16 v[140:141], v201 offset:63488
    ds_read_b64_tr_b16 v[142:143], v201 offset:64000
    s_waitcnt lgkmcnt(12)
    v_mfma_f32_32x32x16_bf16 v[32:47], v[120:123], v[104:107], v[32:47]
    buffer_load_dwordx4 v195, s[12:15], s3 offen offset:1024 lds
    s_waitcnt lgkmcnt(10)
    v_mfma_f32_32x32x16_bf16 v[48:63], v[104:107], v[136:139], v[48:63]
    s_waitcnt lgkmcnt(7)
    v_mfma_f32_32x32x16_bf16 v[32:47], v[116:119], v[100:103], v[32:47]
    s_add_u32 m0, s60, 90112
    s_add_u32 s3, s70, 2048
    buffer_load_dwordx4 v194, s[12:15], s3 offen lds
    s_waitcnt lgkmcnt(5)
    v_mfma_f32_32x32x16_bf16 v[48:63], v[100:103], v[132:135], v[48:63]
    buffer_load_dwordx4 v195, s[12:15], s3 offen offset:1024 lds
    s_waitcnt vmcnt(12)
    s_waitcnt lgkmcnt(0)
    s_barrier
    v_mfma_f32_32x32x16_bf16 v[32:47], v[124:127], v[108:111], v[32:47]
    ds_read_b128 v[96:99], v196 offset:32768
    ds_read_b64_tr_b16 v[112:113], v202 offset:0
    ds_read_b64_tr_b16 v[114:115], v202 offset:512
    ds_read_b64_tr_b16 v[128:129], v202 offset:8192
    ds_read_b64_tr_b16 v[130:131], v202 offset:8704
    v_mfma_f32_32x32x16_bf16 v[48:63], v[108:111], v[140:143], v[48:63]
    ds_read_b128 v[104:107], v198 offset:32768
    ds_read_b64_tr_b16 v[120:121], v202 offset:4096
    ds_read_b64_tr_b16 v[122:123], v202 offset:4608
    ds_read_b64_tr_b16 v[136:137], v202 offset:12288
    ds_read_b64_tr_b16 v[138:139], v202 offset:12800
    s_add_u32 m0, s60, 57344
    s_nop 0
    buffer_load_dwordx4 v192, s[8:11], s79 offen lds
    v_mfma_f32_16x16x32_bf16 v[64:67], v[248:251], v[100:103], v[64:67]
    v_mfma_f32_4x4x4_16b_bf16 v[76:79], v[100:101], v[100:101], v[76:79]
    v_mfma_f32_16x16x32_bf16 v[68:71], v[248:251], v[116:119], v[68:71]
    buffer_load_dwordx4 v193, s[8:11], s79 offen offset:1024 lds
    v_mfma_f32_4x4x4_16b_bf16 v[80:83], v[102:103], v[102:103], v[80:83]
    v_mfma_f32_16x16x32_bf16 v[72:75], v[248:251], v[132:135], v[72:75]
    v_mfma_f32_16x16x32_bf16 v[64:67], v[248:251], v[108:111], v[64:67]
    v_mfma_f32_4x4x4_16b_bf16 v[76:79], v[108:109], v[108:109], v[76:79]
    v_mfma_f32_16x16x32_bf16 v[68:71], v[248:251], v[124:127], v[68:71]
    s_add_u32 m0, s60, 98304
    s_add_u32 s3, s71, 1024
    buffer_load_dwordx4 v194, s[12:15], s3 offen lds
    v_mfma_f32_4x4x4_16b_bf16 v[80:83], v[110:111], v[110:111], v[80:83]
    v_mfma_f32_16x16x32_bf16 v[72:75], v[248:251], v[140:143], v[72:75]
    s_waitcnt lgkmcnt(7)
    v_mfma_f32_32x32x16_bf16 v[32:47], v[112:115], v[96:99], v[32:47]
    ds_read_b128 v[100:103], v197 offset:32768
    ds_read_b64_tr_b16 v[116:117], v203 offset:2048
    ds_read_b64_tr_b16 v[118:119], v203 offset:2560
    ds_read_b64_tr_b16 v[132:133], v203 offset:10240
    ds_read_b64_tr_b16 v[134:135], v203 offset:10752
    s_waitcnt lgkmcnt(10)
    v_mfma_f32_32x32x16_bf16 v[48:63], v[96:99], v[128:131], v[48:63]
    ds_read_b128 v[108:111], v199 offset:32768
    ds_read_b64_tr_b16 v[124:125], v203 offset:6144
    ds_read_b64_tr_b16 v[126:127], v203 offset:6656
    ds_read_b64_tr_b16 v[140:141], v203 offset:14336
    ds_read_b64_tr_b16 v[142:143], v203 offset:14848
    s_waitcnt lgkmcnt(12)
    v_mfma_f32_32x32x16_bf16 v[32:47], v[120:123], v[104:107], v[32:47]
    buffer_load_dwordx4 v195, s[12:15], s3 offen offset:1024 lds
    v_add_u32 v14, 15, v14
    v_lshrrev_b32 v17, 5, v0
    v_lshlrev_b32 v17, 3, v17
    s_lshl_b32 s55, s48, 7
    s_waitcnt lgkmcnt(10)
    v_mfma_f32_32x32x16_bf16 v[48:63], v[104:107], v[136:139], v[48:63]
    s_lshl_b32 s56, s44, 5
    s_add_u32 s55, s55, s56
    buffer_load_dwordx2 v[10:11], v17, s[40:43], s55 offen
    buffer_load_dwordx2 v[12:13], v17, s[40:43], s55 offen offset:16
    s_waitcnt lgkmcnt(7)
    v_mfma_f32_32x32x16_bf16 v[32:47], v[116:119], v[100:103], v[32:47]
    s_add_u32 m0, s60, 106496
    s_add_u32 s3, s71, 2048
    buffer_load_dwordx4 v194, s[12:15], s3 offen lds
    v_lshlrev_b32 v17, 21, v0
    v_add_u32 v17, 0xc000, v17
    s_mov_b64 exec, 0xff
    buffer_load_dword v241, v17, s[28:31], 0 offen
    s_mov_b64 exec, 1
    buffer_load_dword v240, v0, s[32:35], 0 offen
    s_mov_b64 exec, -1
    s_lshl_b32 s55, s45, 4
    s_waitcnt lgkmcnt(5)
    v_mfma_f32_32x32x16_bf16 v[48:63], v[100:103], v[132:135], v[48:63]
    buffer_load_dwordx4 v195, s[12:15], s3 offen offset:1024 lds
    s_add_u32 s55, s55, s46
    s_lshl_b32 s55, s55, 2
    s_add_u32 s55, s55, s44
    v_lshlrev_b32 v17, 7, v0
    s_waitcnt vmcnt(16)
    s_waitcnt lgkmcnt(0)
    s_barrier
    v_mfma_f32_32x32x16_bf16 v[32:47], v[124:127], v[108:111], v[32:47]
    ds_read_b128 v[96:99], v196 offset:40960
    ds_read_b64_tr_b16 v[112:113], v200 offset:0
    ds_read_b64_tr_b16 v[114:115], v200 offset:512
    ds_read_b64_tr_b16 v[128:129], v200 offset:8192
    ds_read_b64_tr_b16 v[130:131], v200 offset:8704
    v_mfma_f32_32x32x16_bf16 v[48:63], v[108:111], v[140:143], v[48:63]
    ds_read_b128 v[104:107], v198 offset:40960
    ds_read_b64_tr_b16 v[120:121], v200 offset:4096
    ds_read_b64_tr_b16 v[122:123], v200 offset:4608
    ds_read_b64_tr_b16 v[136:137], v200 offset:12288
    ds_read_b64_tr_b16 v[138:139], v200 offset:12800
    s_add_u32 m0, s60, 114688
    s_add_u32 s3, s64, 0
    buffer_load_dwordx4 v194, s[12:15], s3 offen lds
    v_mfma_f32_16x16x32_bf16 v[64:67], v[248:251], v[100:103], v[64:67]
    v_mfma_f32_4x4x4_16b_bf16 v[76:79], v[100:101], v[100:101], v[76:79]
    v_mfma_f32_16x16x32_bf16 v[68:71], v[248:251], v[116:119], v[68:71]
    buffer_load_dwordx4 v195, s[12:15], s3 offen offset:1024 lds
    v_mfma_f32_4x4x4_16b_bf16 v[80:83], v[102:103], v[102:103], v[80:83]
    v_mfma_f32_16x16x32_bf16 v[72:75], v[248:251], v[132:135], v[72:75]
    v_mfma_f32_16x16x32_bf16 v[64:67], v[248:251], v[108:111], v[64:67]
    v_mfma_f32_4x4x4_16b_bf16 v[76:79], v[108:109], v[108:109], v[76:79]
    v_mfma_f32_16x16x32_bf16 v[68:71], v[248:251], v[124:127], v[68:71]
    s_add_u32 m0, s60, 122880
    s_add_u32 s3, s65, 0
    buffer_load_dwordx4 v194, s[12:15], s3 offen lds
    v_mfma_f32_4x4x4_16b_bf16 v[80:83], v[110:111], v[110:111], v[80:83]
    v_mfma_f32_16x16x32_bf16 v[72:75], v[248:251], v[140:143], v[72:75]
    s_waitcnt lgkmcnt(7)
    v_mfma_f32_32x32x16_bf16 v[32:47], v[112:115], v[96:99], v[32:47]
    ds_read_b128 v[100:103], v197 offset:40960
    ds_read_b64_tr_b16 v[116:117], v201 offset:2048
    ds_read_b64_tr_b16 v[118:119], v201 offset:2560
    ds_read_b64_tr_b16 v[132:133], v201 offset:10240
    ds_read_b64_tr_b16 v[134:135], v201 offset:10752
    s_waitcnt lgkmcnt(10)
    v_mfma_f32_32x32x16_bf16 v[48:63], v[96:99], v[128:131], v[48:63]
    ds_read_b128 v[108:111], v199 offset:40960
    ds_read_b64_tr_b16 v[124:125], v201 offset:6144
    ds_read_b64_tr_b16 v[126:127], v201 offset:6656
    ds_read_b64_tr_b16 v[140:141], v201 offset:14336
    ds_read_b64_tr_b16 v[142:143], v201 offset:14848
    s_waitcnt lgkmcnt(12)
    v_mfma_f32_32x32x16_bf16 v[32:47], v[120:123], v[104:107], v[32:47]
    buffer_load_dwordx4 v195, s[12:15], s3 offen offset:1024 lds
    s_lshl_b32 s55, s55, 9
    s_mov_b64 exec, 0xf
    buffer_load_dword v245, v17, s[16:19], s55 offen
    s_mov_b64 exec, -1
    v_bfe_u32 v17, v0, 4, 1
    v_lshrrev_b32 v18, 5, v0
    s_waitcnt lgkmcnt(10)
    v_mfma_f32_32x32x16_bf16 v[48:63], v[104:107], v[136:139], v[48:63]
    v_and_b32 v183, 15, v0
    v_lshlrev_b32 v183, 4, v183
    v_lshl_add_u32 v183, v18, 8, v183
    v_lshl_add_u32 v180, v17, 16, v183
    s_waitcnt lgkmcnt(7)
    v_mfma_f32_32x32x16_bf16 v[32:47], v[116:119], v[100:103], v[32:47]
    v_lshl_add_u32 v182, v17, 11, v183
    s_lshl_b32 s54, s61, 12
    s_lshl_b32 s59, s62, 10
    s_add_u32 s54, s54, s59
    s_waitcnt lgkmcnt(5)
    v_mfma_f32_32x32x16_bf16 v[48:63], v[100:103], v[132:135], v[48:63]
    s_add_u32 s54, s54, 98304
    v_add_u32 v181, s54, v1
    v_add_u32 v182, s54, v182
    s_lshl_b32 s55, s44, 10
    s_waitcnt vmcnt(15)
    s_waitcnt lgkmcnt(0)
    s_barrier
    v_mfma_f32_32x32x16_bf16 v[32:47], v[124:127], v[108:111], v[32:47]
    ds_read_b128 v[96:99], v196 offset:49152
    ds_read_b64_tr_b16 v[112:113], v200 offset:16384
    ds_read_b64_tr_b16 v[114:115], v200 offset:16896
    ds_read_b64_tr_b16 v[128:129], v200 offset:24576
    ds_read_b64_tr_b16 v[130:131], v200 offset:25088
    v_mfma_f32_32x32x16_bf16 v[48:63], v[108:111], v[140:143], v[48:63]
    ds_read_b128 v[104:107], v198 offset:49152
    ds_read_b64_tr_b16 v[120:121], v200 offset:20480
    ds_read_b64_tr_b16 v[122:123], v200 offset:20992
    ds_read_b64_tr_b16 v[136:137], v200 offset:28672
    ds_read_b64_tr_b16 v[138:139], v200 offset:29184
    s_add_u32 m0, s60, 131072
    s_add_u32 s3, s66, 0
    buffer_load_dwordx4 v194, s[12:15], s3 offen lds
    v_mfma_f32_16x16x32_bf16 v[64:67], v[248:251], v[100:103], v[64:67]
    v_mfma_f32_4x4x4_16b_bf16 v[76:79], v[100:101], v[100:101], v[76:79]
    v_mfma_f32_16x16x32_bf16 v[68:71], v[248:251], v[116:119], v[68:71]
    buffer_load_dwordx4 v195, s[12:15], s3 offen offset:1024 lds
    v_mfma_f32_4x4x4_16b_bf16 v[80:83], v[102:103], v[102:103], v[80:83]
    v_mfma_f32_16x16x32_bf16 v[72:75], v[248:251], v[132:135], v[72:75]
    v_mfma_f32_16x16x32_bf16 v[64:67], v[248:251], v[108:111], v[64:67]
    v_mfma_f32_4x4x4_16b_bf16 v[76:79], v[108:109], v[108:109], v[76:79]
    v_mfma_f32_16x16x32_bf16 v[68:71], v[248:251], v[124:127], v[68:71]
    s_add_u32 m0, s60, 139264
    s_add_u32 s3, s67, 0
    buffer_load_dwordx4 v194, s[12:15], s3 offen lds
    v_mfma_f32_4x4x4_16b_bf16 v[80:83], v[110:111], v[110:111], v[80:83]
    v_mfma_f32_16x16x32_bf16 v[72:75], v[248:251], v[140:143], v[72:75]
    s_waitcnt lgkmcnt(7)
    v_mfma_f32_32x32x16_bf16 v[32:47], v[112:115], v[96:99], v[32:47]
    ds_read_b128 v[100:103], v197 offset:49152
    ds_read_b64_tr_b16 v[116:117], v201 offset:18432
    ds_read_b64_tr_b16 v[118:119], v201 offset:18944
    ds_read_b64_tr_b16 v[132:133], v201 offset:26624
    ds_read_b64_tr_b16 v[134:135], v201 offset:27136
    s_waitcnt lgkmcnt(10)
    v_mfma_f32_32x32x16_bf16 v[48:63], v[96:99], v[128:131], v[48:63]
    ds_read_b128 v[108:111], v199 offset:49152
    ds_read_b64_tr_b16 v[124:125], v201 offset:22528
    ds_read_b64_tr_b16 v[126:127], v201 offset:23040
    ds_read_b64_tr_b16 v[140:141], v201 offset:30720
    ds_read_b64_tr_b16 v[142:143], v201 offset:31232
    s_waitcnt lgkmcnt(12)
    v_mfma_f32_32x32x16_bf16 v[32:47], v[120:123], v[104:107], v[32:47]
    buffer_load_dwordx4 v195, s[12:15], s3 offen offset:1024 lds
    s_add_u32 s55, s55, 147456
    v_add_u32 v17, s55, v1
    v_xor_b32 v18, 1024, v17
    v_xor_b32 v19, 2048, v17
    s_waitcnt lgkmcnt(10)
    v_mfma_f32_32x32x16_bf16 v[48:63], v[104:107], v[136:139], v[48:63]
    s_lshl_b32 s54, s48, 1
    s_add_u32 s54, s54, s61
    s_lshl_b32 s54, s54, 7
    s_lshl_b32 s55, s47, 1
    s_waitcnt lgkmcnt(7)
    v_mfma_f32_32x32x16_bf16 v[32:47], v[116:119], v[100:103], v[32:47]
    s_add_u32 s54, s54, s55
    s_add_u32 s54, s54, s62
    s_lshl_b32 s54, s54, 10
    s_add_u32 s55, s54, 0x10000
    s_waitcnt lgkmcnt(5)
    v_mfma_f32_32x32x16_bf16 v[48:63], v[100:103], v[132:135], v[48:63]
    s_add_u32 s56, s54, 0x20000
    s_add_u32 s57, s54, 0x210000
    s_waitcnt vmcnt(9)
    s_waitcnt lgkmcnt(0)
    s_barrier
    v_mfma_f32_32x32x16_bf16 v[32:47], v[124:127], v[108:111], v[32:47]
    ds_read_b128 v[96:99], v196 offset:57344
    ds_read_b64_tr_b16 v[112:113], v200 offset:32768
    ds_read_b64_tr_b16 v[114:115], v200 offset:33280
    ds_read_b64_tr_b16 v[128:129], v200 offset:40960
    ds_read_b64_tr_b16 v[130:131], v200 offset:41472
    v_mfma_f32_32x32x16_bf16 v[48:63], v[108:111], v[140:143], v[48:63]
    ds_read_b128 v[104:107], v198 offset:57344
    ds_read_b64_tr_b16 v[120:121], v200 offset:36864
    ds_read_b64_tr_b16 v[122:123], v200 offset:37376
    ds_read_b64_tr_b16 v[136:137], v200 offset:45056
    ds_read_b64_tr_b16 v[138:139], v200 offset:45568
    s_add_u32 m0, s60, 65536
    s_add_u32 s3, s68, 0
    buffer_load_dwordx4 v194, s[12:15], s3 offen lds
    v_mfma_f32_16x16x32_bf16 v[64:67], v[248:251], v[100:103], v[64:67]
    v_mfma_f32_4x4x4_16b_bf16 v[76:79], v[100:101], v[100:101], v[76:79]
    v_mfma_f32_16x16x32_bf16 v[68:71], v[248:251], v[116:119], v[68:71]
    buffer_load_dwordx4 v195, s[12:15], s3 offen offset:1024 lds
    v_mfma_f32_4x4x4_16b_bf16 v[80:83], v[102:103], v[102:103], v[80:83]
    v_mfma_f32_16x16x32_bf16 v[72:75], v[248:251], v[132:135], v[72:75]
    v_mfma_f32_16x16x32_bf16 v[64:67], v[248:251], v[108:111], v[64:67]
    v_mfma_f32_4x4x4_16b_bf16 v[76:79], v[108:109], v[108:109], v[76:79]
    v_mfma_f32_16x16x32_bf16 v[68:71], v[248:251], v[124:127], v[68:71]
    s_add_u32 m0, s60, 73728
    s_add_u32 s3, s69, 0
    buffer_load_dwordx4 v194, s[12:15], s3 offen lds
    v_mfma_f32_4x4x4_16b_bf16 v[80:83], v[110:111], v[110:111], v[80:83]
    v_mfma_f32_16x16x32_bf16 v[72:75], v[248:251], v[140:143], v[72:75]
    s_waitcnt lgkmcnt(7)
    v_mfma_f32_32x32x16_bf16 v[32:47], v[112:115], v[96:99], v[32:47]
    ds_read_b128 v[100:103], v197 offset:57344
    ds_read_b64_tr_b16 v[116:117], v201 offset:34816
    ds_read_b64_tr_b16 v[118:119], v201 offset:35328
    ds_read_b64_tr_b16 v[132:133], v201 offset:43008
    ds_read_b64_tr_b16 v[134:135], v201 offset:43520
    s_waitcnt lgkmcnt(10)
    v_mfma_f32_32x32x16_bf16 v[48:63], v[96:99], v[128:131], v[48:63]
    ds_read_b128 v[108:111], v199 offset:57344
    ds_read_b64_tr_b16 v[124:125], v201 offset:38912
    ds_read_b64_tr_b16 v[126:127], v201 offset:39424
    ds_read_b64_tr_b16 v[140:141], v201 offset:47104
    ds_read_b64_tr_b16 v[142:143], v201 offset:47616
    s_waitcnt lgkmcnt(12)
    v_mfma_f32_32x32x16_bf16 v[32:47], v[120:123], v[104:107], v[32:47]
    buffer_load_dwordx4 v195, s[12:15], s3 offen offset:1024 lds
    s_waitcnt lgkmcnt(10)
    v_mfma_f32_32x32x16_bf16 v[48:63], v[104:107], v[136:139], v[48:63]
    s_add_u32 m0, s60, 81920
    s_add_u32 s3, s70, 0
    buffer_load_dwordx4 v194, s[12:15], s3 offen lds
    s_waitcnt lgkmcnt(7)
    v_mfma_f32_32x32x16_bf16 v[32:47], v[116:119], v[100:103], v[32:47]
    buffer_load_dwordx4 v195, s[12:15], s3 offen offset:1024 lds
    ds_read_b64 v[2:3], v154 offset:0
    ds_read_b64 v[4:5], v155 offset:0
    s_waitcnt lgkmcnt(7)
    v_mfma_f32_32x32x16_bf16 v[48:63], v[100:103], v[132:135], v[48:63]
    s_add_u32 m0, s60, 90112
    s_add_u32 s3, s71, 0
    buffer_load_dwordx4 v194, s[12:15], s3 offen lds
    ds_read_b64 v[6:7], v154 offset:4096
    ds_read_b64 v[8:9], v155 offset:4096
    s_lshl_b32 s0, s44, 13
    buffer_load_dwordx4 v195, s[12:15], s3 offen offset:1024 lds
    v_mfma_f32_16x16x32_bf16 v[64:67], v[248:251], v[100:103], v[64:67]
    v_mfma_f32_4x4x4_16b_bf16 v[76:79], v[100:101], v[100:101], v[76:79]
    v_mfma_f32_16x16x32_bf16 v[68:71], v[248:251], v[116:119], v[68:71]
    v_mfma_f32_4x4x4_16b_bf16 v[80:83], v[102:103], v[102:103], v[80:83]
    v_mfma_f32_16x16x32_bf16 v[72:75], v[248:251], v[132:135], v[72:75]
    s_waitcnt lgkmcnt(8)
    v_mfma_f32_16x16x32_bf16 v[64:67], v[248:251], v[108:111], v[64:67]
    v_mfma_f32_4x4x4_16b_bf16 v[76:79], v[108:109], v[108:109], v[76:79]
    s_waitcnt lgkmcnt(6)
    v_mfma_f32_16x16x32_bf16 v[68:71], v[248:251], v[124:127], v[68:71]
    v_mfma_f32_4x4x4_16b_bf16 v[80:83], v[110:111], v[110:111], v[80:83]
    s_waitcnt lgkmcnt(4)
    v_mfma_f32_16x16x32_bf16 v[72:75], v[248:251], v[140:143], v[72:75]
    v_mfma_f32_32x32x16_bf16 v[32:47], v[124:127], v[108:111], v[32:47]
    s_nop 1
    v_add_f32 v76, v76, v80
    v_add_f32 v77, v77, v81
    v_add_f32 v78, v78, v82
    v_add_f32 v79, v79, v83
    v_mfma_f32_32x32x16_bf16 v[48:63], v[108:111], v[140:143], v[48:63]
    v_cndmask_b32 v87, v76, v77, s[80:81]
    v_mov_b32 v84, v68
    v_cndmask_b32 v87, v87, v78, s[82:83]
    v_mov_b32 v86, v64
    v_cndmask_b32 v87, v87, v79, s[84:85]
    v_mov_b32 v85, v72
    v_mov_b32 v88, v87
    s_nop 1
    v_permlane32_swap_b32 v87, v88
    v_add_f32 v87, v87, v88
    ds_write_b128 v17, v[84:87]
    s_waitcnt lgkmcnt(0)
    s_waitcnt vmcnt(13)
    s_barrier
    ds_read_b64 v[90:91], v19 offset:8
    ds_read_b64 v[88:89], v18
    s_waitcnt lgkmcnt(1)
    v_add_f32 v86, v86, v90
    v_add_f32 v87, v87, v91
    v_mul_f32 v152, 0xbb000000, v86
    s_waitcnt lgkmcnt(0)
    v_add_f32 v84, v84, v88
    v_cvt_pk_bf16_f32 v153, v152, v152
    v_and_b32 v155, 0xffff0000, v153
    v_sub_f32 v154, v152, v155
    v_cvt_pk_bf16_f32 v160, v152, v154
    v_and_b32 v161, 0xffff, v153
    v_cvt_pk_bf16_f32 v164, v84, v84
    v_and_b32 v155, 0xffff0000, v164
    v_sub_f32 v154, v84, v155
    v_cndmask_b32 v160, 0, v160, s[96:97]
    v_cndmask_b32 v161, 0, v161, s[96:97]
    v_cvt_pk_bf16_f32 v165, v154, 0
    v_add_f32 v85, v85, v89
    v_mul_f32 v153, 0x3b000000, v87
    v_mfma_f32_32x32x16_bf16 v[32:47], v[164:167], v[160:163], v[32:47]
    v_fma_f32 v153, -v152, v152, v153
    v_max_f32 v153, 0, v153
    v_add_f32 v153, 0x3727c5ac, v153
    v_rsq_f32 v156, v153
    v_cvt_pk_bf16_f32 v168, v85, v85
    v_and_b32 v155, 0xffff0000, v168
    v_sub_f32 v154, v85, v155
    v_cvt_pk_bf16_f32 v169, v154, 0
    v_cvt_pk_bf16_f32 v153, v156, v156
    v_and_b32 v155, 0xffff0000, v153
    v_sub_f32 v154, v156, v155
    v_mfma_f32_32x32x16_bf16 v[48:63], v[160:163], v[168:171], v[48:63]
    v_cvt_pk_bf16_f32 v172, v156, v154
    v_cndmask_b32 v172, 0, v172, s[96:97]
    v_mul_f32 v157, 0x3eb8aa3b, v156
    v_mul_f32 v32, v32, v156
    v_mul_f32 v33, v33, v156
    v_mul_f32 v34, v34, v156
    v_mfma_f32_32x32x16_bf16 v[80:95], v[172:175], v[176:179], 0
    v_mul_f32 v35, v35, v156
    v_mul_f32 v36, v36, v156
    v_mul_f32 v37, v37, v156
    v_mul_f32 v38, v38, v156
    v_mul_f32 v39, v39, v156
    v_cvt_pk_bf16_f32 v96, v32, v33
    v_cvt_pk_bf16_f32 v97, v34, v35
    v_cvt_pk_bf16_f32 v98, v36, v37
    v_cvt_pk_bf16_f32 v99, v38, v39
    buffer_store_dwordx4 v[96:99], v1, s[28:31], s55 offen sc1
    v_mul_f32 v40, v40, v156
    v_mul_f32 v41, v41, v156
    v_mul_f32 v42, v42, v156
    v_mul_f32 v43, v43, v156
    v_mul_f32 v44, v44, v156
    v_mul_f32 v45, v45, v156
    v_mul_f32 v46, v46, v156
    v_mul_f32 v47, v47, v156
    v_cvt_pk_bf16_f32 v100, v40, v41
    v_cvt_pk_bf16_f32 v101, v42, v43
    v_cvt_pk_bf16_f32 v102, v44, v45
    v_cvt_pk_bf16_f32 v103, v46, v47
    buffer_store_dwordx4 v[100:103], v1, s[28:31], s56 offen sc1
    ds_read_b128 v[112:115], v196 offset:0
    ds_read_b64_tr_b16 v[128:129], v200 offset:49152
    ds_read_b64_tr_b16 v[130:131], v200 offset:49664
    ds_read_b128 v[116:119], v197 offset:0
    ds_read_b64_tr_b16 v[132:133], v201 offset:51200
    ds_read_b64_tr_b16 v[134:135], v201 offset:51712
    ds_read_b128 v[120:123], v198 offset:0
    ds_read_b64_tr_b16 v[136:137], v200 offset:53248
    ds_read_b64_tr_b16 v[138:139], v200 offset:53760
    ds_read_b128 v[124:127], v199 offset:0
    ds_read_b64_tr_b16 v[140:141], v201 offset:55296
    ds_read_b64_tr_b16 v[142:143], v201 offset:55808
    v_pk_mul_f32 v[48:49], v[48:49], v[80:81]
    v_pk_mul_f32 v[50:51], v[50:51], v[82:83]
    v_pk_mul_f32 v[52:53], v[52:53], v[84:85]
    v_pk_mul_f32 v[54:55], v[54:55], v[86:87]
    v_cvt_pk_bf16_f32 v104, v48, v49
    v_cvt_pk_bf16_f32 v105, v50, v51
    v_cvt_pk_bf16_f32 v106, v52, v53
    v_cvt_pk_bf16_f32 v107, v54, v55
    buffer_store_dwordx4 v[104:107], v180, s[28:31], s57 offen offset:0 sc1
    v_pk_mul_f32 v[56:57], v[56:57], v[88:89]
    v_pk_mul_f32 v[58:59], v[58:59], v[90:91]
    v_pk_mul_f32 v[60:61], v[60:61], v[92:93]
    v_pk_mul_f32 v[62:63], v[62:63], v[94:95]
    v_cvt_pk_bf16_f32 v108, v56, v57
    v_cvt_pk_bf16_f32 v109, v58, v59
    v_cvt_pk_bf16_f32 v110, v60, v61
    v_cvt_pk_bf16_f32 v111, v62, v63
    buffer_store_dwordx4 v[108:111], v180, s[28:31], s57 offen offset:512 sc1
    s_mov_b64 exec, 16383
    buffer_load_dword v243, v244, s[20:23], s86 offen
    s_mov_b64 exec, 31
    buffer_load_dword v244, v244, s[24:27], s87 offen
    s_mov_b64 exec, -1
    ds_write_b128 v181, v[96:99]
    ds_write_b128 v181, v[100:103] offset:2048
    ds_write_b128 v182, v[104:107] offset:8192
    ds_write_b128 v182, v[108:111] offset:8704
    s_waitcnt lgkmcnt(13)
    v_mfma_f32_32x32x16_bf16 v[64:79], v[128:131], v[112:115], 0
    ds_read_b128 v[204:207], v196 offset:8192
    ds_read_b64_tr_b16 v[220:221], v200 offset:57344
    ds_read_b64_tr_b16 v[222:223], v200 offset:57856
    s_mov_b32 s64, 0xffffffff
    s_mov_b32 s65, 0xfffffff0
    v_mfma_f32_16x16x32_bf16 v[80:83], v[248:251], v[128:131], 0
    s_waitcnt lgkmcnt(13)
    v_mfma_f32_32x32x16_bf16 v[64:79], v[132:135], v[116:119], v[64:79]
    ds_read_b128 v[208:211], v197 offset:8192
    ds_read_b64_tr_b16 v[224:225], v201 offset:59392
    ds_read_b64_tr_b16 v[226:227], v201 offset:59904
    s_mov_b32 s66, 0xfffffffe
    s_mov_b32 s67, 0xffffffe0
    v_mfma_f32_16x16x32_bf16 v[80:83], v[248:251], v[132:135], v[80:83]
    s_waitcnt lgkmcnt(13)
    v_mfma_f32_32x32x16_bf16 v[64:79], v[136:139], v[120:123], v[64:79]
    ds_read_b128 v[212:215], v198 offset:8192
    ds_read_b64_tr_b16 v[228:229], v200 offset:61440
    ds_read_b64_tr_b16 v[230:231], v200 offset:61952
    s_mov_b32 s68, 0xfffffffc
    s_mov_b32 s69, 0xffffffc0
    v_mfma_f32_16x16x32_bf16 v[80:83], v[248:251], v[136:139], v[80:83]
    s_waitcnt lgkmcnt(13)
    v_mfma_f32_32x32x16_bf16 v[64:79], v[140:143], v[124:127], v[64:79]
    ds_read_b128 v[216:219], v199 offset:8192
    ds_read_b64_tr_b16 v[232:233], v201 offset:63488
    ds_read_b64_tr_b16 v[234:235], v201 offset:64000
    s_mov_b32 s70, 0xfffffff8
    s_mov_b32 s71, 0xffffff80
    v_mfma_f32_16x16x32_bf16 v[80:83], v[248:251], v[140:143], v[80:83]
    s_waitcnt vmcnt(14)
    s_barrier
    s_waitcnt lgkmcnt(9)
    v_mfma_f32_32x32x16_bf16 v[64:79], v[220:223], v[204:207], v[64:79]
    ds_read_b128 v[112:115], v196 offset:16384
    ds_read_b64_tr_b16 v[128:129], v202 offset:0
    ds_read_b64_tr_b16 v[130:131], v202 offset:512
    s_mov_b32 s72, 0xffffff00
    s_mov_b32 s73, 0xfffff000
    v_mfma_f32_16x16x32_bf16 v[80:83], v[248:251], v[220:223], v[80:83]
    s_waitcnt lgkmcnt(9)
    v_mfma_f32_32x32x16_bf16 v[64:79], v[224:227], v[208:211], v[64:79]
    ds_read_b128 v[116:119], v197 offset:16384
    ds_read_b64_tr_b16 v[132:133], v203 offset:2048
    ds_read_b64_tr_b16 v[134:135], v203 offset:2560
    s_mov_b32 s74, 0xfffffe00
    s_mov_b32 s75, 0xffffe000
    v_mfma_f32_16x16x32_bf16 v[80:83], v[248:251], v[224:227], v[80:83]
    s_waitcnt lgkmcnt(9)
    v_mfma_f32_32x32x16_bf16 v[64:79], v[228:231], v[212:215], v[64:79]
    ds_read_b128 v[120:123], v198 offset:16384
    ds_read_b64_tr_b16 v[136:137], v202 offset:4096
    ds_read_b64_tr_b16 v[138:139], v202 offset:4608
    s_mov_b32 s76, 0xfffffc00
    s_mov_b32 s77, 0xffffc000
    v_mfma_f32_16x16x32_bf16 v[80:83], v[248:251], v[228:231], v[80:83]
    s_waitcnt lgkmcnt(9)
    v_mfma_f32_32x32x16_bf16 v[64:79], v[232:235], v[216:219], v[64:79]
    ds_read_b128 v[124:127], v199 offset:16384
    ds_read_b64_tr_b16 v[140:141], v203 offset:6144
    ds_read_b64_tr_b16 v[142:143], v203 offset:6656
    s_mov_b32 s78, 0xfffff800
    s_mov_b32 s79, 0xffff8000
    v_mfma_f32_16x16x32_bf16 v[80:83], v[248:251], v[232:235], v[80:83]
    s_waitcnt lgkmcnt(9)
    v_mfma_f32_32x32x16_bf16 v[64:79], v[128:131], v[112:115], v[64:79]
    ds_read_b128 v[204:207], v196 offset:24576
    ds_read_b64_tr_b16 v[220:221], v202 offset:8192
    ds_read_b64_tr_b16 v[222:223], v202 offset:8704
    s_mov_b32 s80, 0xffff0000
    s_mov_b32 s81, 0xfff00000
    v_mfma_f32_16x16x32_bf16 v[80:83], v[248:251], v[128:131], v[80:83]
    s_waitcnt lgkmcnt(9)
    v_mfma_f32_32x32x16_bf16 v[64:79], v[132:135], v[116:119], v[64:79]
    ds_read_b128 v[208:211], v197 offset:24576
    ds_read_b64_tr_b16 v[224:225], v203 offset:10240
    ds_read_b64_tr_b16 v[226:227], v203 offset:10752
    s_mov_b32 s82, 0xfffe0000
    s_mov_b32 s83, 0xffe00000
    v_mfma_f32_16x16x32_bf16 v[80:83], v[248:251], v[132:135], v[80:83]
    s_waitcnt lgkmcnt(9)
    v_mfma_f32_32x32x16_bf16 v[64:79], v[136:139], v[120:123], v[64:79]
    ds_read_b128 v[212:215], v198 offset:24576
    ds_read_b64_tr_b16 v[228:229], v202 offset:12288
    ds_read_b64_tr_b16 v[230:231], v202 offset:12800
    s_mov_b32 s84, 0xfffc0000
    s_mov_b32 s85, 0xffc00000
    v_mfma_f32_16x16x32_bf16 v[80:83], v[248:251], v[136:139], v[80:83]
    s_waitcnt lgkmcnt(9)
    v_mfma_f32_32x32x16_bf16 v[64:79], v[140:143], v[124:127], v[64:79]
    ds_read_b128 v[216:219], v199 offset:24576
    ds_read_b64_tr_b16 v[232:233], v203 offset:14336
    ds_read_b64_tr_b16 v[234:235], v203 offset:14848
    s_mov_b32 s86, 0xfff80000
    s_mov_b32 s87, 0xff800000
    v_mfma_f32_16x16x32_bf16 v[80:83], v[248:251], v[140:143], v[80:83]
    s_waitcnt lgkmcnt(9)
    v_mfma_f32_32x32x16_bf16 v[64:79], v[220:223], v[204:207], v[64:79]
    ds_read_b128 v[112:115], v196 offset:32768
    ds_read_b64_tr_b16 v[128:129], v200 offset:0
    ds_read_b64_tr_b16 v[130:131], v200 offset:512
    s_mov_b32 s88, 0xff000000
    s_mov_b32 s89, 0xf0000000
    v_mfma_f32_16x16x32_bf16 v[80:83], v[248:251], v[220:223], v[80:83]
    s_waitcnt lgkmcnt(9)
    v_mfma_f32_32x32x16_bf16 v[64:79], v[224:227], v[208:211], v[64:79]
    ds_read_b128 v[116:119], v197 offset:32768
    ds_read_b64_tr_b16 v[132:133], v201 offset:2048
    ds_read_b64_tr_b16 v[134:135], v201 offset:2560
    s_mov_b32 s90, 0xfe000000
    s_mov_b32 s91, 0xe0000000
    v_mfma_f32_16x16x32_bf16 v[80:83], v[248:251], v[224:227], v[80:83]
    s_waitcnt lgkmcnt(9)
    v_mfma_f32_32x32x16_bf16 v[64:79], v[228:231], v[212:215], v[64:79]
    ds_read_b128 v[120:123], v198 offset:32768
    ds_read_b64_tr_b16 v[136:137], v200 offset:4096
    ds_read_b64_tr_b16 v[138:139], v200 offset:4608
    s_mov_b32 s92, 0xfc000000
    s_mov_b32 s93, 0xc0000000
    v_mfma_f32_16x16x32_bf16 v[80:83], v[248:251], v[228:231], v[80:83]
    s_waitcnt lgkmcnt(9)
    v_mfma_f32_32x32x16_bf16 v[64:79], v[232:235], v[216:219], v[64:79]
    ds_read_b128 v[124:127], v199 offset:32768
    ds_read_b64_tr_b16 v[140:141], v201 offset:6144
    ds_read_b64_tr_b16 v[142:143], v201 offset:6656
    s_mov_b32 s94, 0xf8000000
    s_mov_b32 s95, 0x80000000
    v_add_u32 v181, 20480, v181
    v_mfma_f32_16x16x32_bf16 v[80:83], v[248:251], v[232:235], v[80:83]
    s_waitcnt vmcnt(6)
    s_barrier
    s_lshl_b32 s55, s45, 7
    buffer_load_dwordx2 v[146:147], v149, s[28:31], s55 offen offset:1024 sc1
    s_waitcnt vmcnt(3)
    s_mov_b64 exec, 15
    s_mov_b32 s55, 0x2000
    buffer_store_dwordx2 v[14:15], v148, s[28:31], s55 offen sc1
    s_mov_b64 exec, -1
    s_waitcnt lgkmcnt(9)
    v_mfma_f32_32x32x16_bf16 v[64:79], v[128:131], v[112:115], v[64:79]
    ds_read_b128 v[204:207], v196 offset:40960
    ds_read_b64_tr_b16 v[220:221], v200 offset:8192
    ds_read_b64_tr_b16 v[222:223], v200 offset:8704
    s_add_u32 m0, s0, 131072
    s_add_u32 s3, s2, 0
    buffer_load_dwordx4 v20, s[16:19], s3 offen lds
    v_mfma_f32_16x16x32_bf16 v[80:83], v[248:251], v[128:131], v[80:83]
    s_waitcnt lgkmcnt(9)
    v_mfma_f32_32x32x16_bf16 v[64:79], v[132:135], v[116:119], v[64:79]
    ds_read_b128 v[208:211], v197 offset:40960
    ds_read_b64_tr_b16 v[224:225], v201 offset:10240
    ds_read_b64_tr_b16 v[226:227], v201 offset:10752
    buffer_load_dwordx4 v236, s[16:19], s3 offen offset:1024 lds
    v_mfma_f32_16x16x32_bf16 v[80:83], v[248:251], v[132:135], v[80:83]
    s_waitcnt lgkmcnt(9)
    v_mfma_f32_32x32x16_bf16 v[64:79], v[136:139], v[120:123], v[64:79]
    ds_read_b128 v[212:215], v198 offset:40960
    ds_read_b64_tr_b16 v[228:229], v200 offset:12288
    ds_read_b64_tr_b16 v[230:231], v200 offset:12800
    buffer_load_dwordx4 v237, s[16:19], s3 offen offset:2048 lds
    v_mfma_f32_16x16x32_bf16 v[80:83], v[248:251], v[136:139], v[80:83]
    s_waitcnt lgkmcnt(9)
    v_mfma_f32_32x32x16_bf16 v[64:79], v[140:143], v[124:127], v[64:79]
    ds_read_b128 v[216:219], v199 offset:40960
    ds_read_b64_tr_b16 v[232:233], v201 offset:14336
    ds_read_b64_tr_b16 v[234:235], v201 offset:14848
    buffer_load_dwordx4 v238, s[16:19], s3 offen offset:3072 lds
    v_mfma_f32_16x16x32_bf16 v[80:83], v[248:251], v[140:143], v[80:83]
    s_waitcnt lgkmcnt(9)
    v_mfma_f32_32x32x16_bf16 v[64:79], v[220:223], v[204:207], v[64:79]
    ds_read_b128 v[112:115], v196 offset:49152
    ds_read_b64_tr_b16 v[128:129], v200 offset:16384
    ds_read_b64_tr_b16 v[130:131], v200 offset:16896
    s_add_u32 m0, s0, 135168
    s_add_u32 s3, s2, 32768
    buffer_load_dwordx4 v20, s[16:19], s3 offen lds
    v_mfma_f32_16x16x32_bf16 v[80:83], v[248:251], v[220:223], v[80:83]
    s_waitcnt lgkmcnt(9)
    v_mfma_f32_32x32x16_bf16 v[64:79], v[224:227], v[208:211], v[64:79]
    ds_read_b128 v[116:119], v197 offset:49152
    ds_read_b64_tr_b16 v[132:133], v201 offset:18432
    ds_read_b64_tr_b16 v[134:135], v201 offset:18944
    buffer_load_dwordx4 v236, s[16:19], s3 offen offset:1024 lds
    v_mfma_f32_16x16x32_bf16 v[80:83], v[248:251], v[224:227], v[80:83]
    s_waitcnt lgkmcnt(9)
    v_mfma_f32_32x32x16_bf16 v[64:79], v[228:231], v[212:215], v[64:79]
    ds_read_b128 v[120:123], v198 offset:49152
    ds_read_b64_tr_b16 v[136:137], v200 offset:20480
    ds_read_b64_tr_b16 v[138:139], v200 offset:20992
    buffer_load_dwordx4 v237, s[16:19], s3 offen offset:2048 lds
    v_mfma_f32_16x16x32_bf16 v[80:83], v[248:251], v[228:231], v[80:83]
    s_waitcnt lgkmcnt(9)
    v_mfma_f32_32x32x16_bf16 v[64:79], v[232:235], v[216:219], v[64:79]
    ds_read_b128 v[124:127], v199 offset:49152
    ds_read_b64_tr_b16 v[140:141], v201 offset:22528
    ds_read_b64_tr_b16 v[142:143], v201 offset:23040
    buffer_load_dwordx4 v238, s[16:19], s3 offen offset:3072 lds
    v_mfma_f32_16x16x32_bf16 v[80:83], v[248:251], v[232:235], v[80:83]
    s_waitcnt lgkmcnt(9)
    v_mfma_f32_32x32x16_bf16 v[64:79], v[128:131], v[112:115], v[64:79]
    ds_read_b128 v[204:207], v196 offset:57344
    ds_read_b64_tr_b16 v[220:221], v200 offset:24576
    ds_read_b64_tr_b16 v[222:223], v200 offset:25088
    s_min_u32 s55, s47, 4
    v_mfma_f32_16x16x32_bf16 v[80:83], v[248:251], v[128:131], v[80:83]
    s_waitcnt lgkmcnt(9)
    v_mfma_f32_32x32x16_bf16 v[64:79], v[132:135], v[116:119], v[64:79]
    ds_read_b128 v[208:211], v197 offset:57344
    ds_read_b64_tr_b16 v[224:225], v201 offset:26624
    ds_read_b64_tr_b16 v[226:227], v201 offset:27136
    s_lshl_b32 s55, s55, 1
    s_lshl_b32 s56, 1, s55
    v_mfma_f32_16x16x32_bf16 v[80:83], v[248:251], v[132:135], v[80:83]
    s_waitcnt lgkmcnt(9)
    v_mfma_f32_32x32x16_bf16 v[64:79], v[136:139], v[120:123], v[64:79]
    ds_read_b128 v[212:215], v198 offset:57344
    ds_read_b64_tr_b16 v[228:229], v200 offset:28672
    ds_read_b64_tr_b16 v[230:231], v200 offset:29184
    s_sub_u32 s56, s56, 1
    v_mfma_f32_16x16x32_bf16 v[80:83], v[248:251], v[136:139], v[80:83]
    s_waitcnt lgkmcnt(9)
    v_mfma_f32_32x32x16_bf16 v[64:79], v[140:143], v[124:127], v[64:79]
    ds_read_b128 v[216:219], v199 offset:57344
    ds_read_b64_tr_b16 v[232:233], v201 offset:30720
    ds_read_b64_tr_b16 v[234:235], v201 offset:31232
    s_mov_b32 s57, 0
    s_add_u32 s55, s50, 15
    v_mfma_f32_16x16x32_bf16 v[80:83], v[248:251], v[140:143], v[80:83]
    s_waitcnt lgkmcnt(9)
    v_mfma_f32_32x32x16_bf16 v[64:79], v[220:223], v[204:207], v[64:79]
    s_lshl_b32 s59, s44, 11
    v_mfma_f32_16x16x32_bf16 v[80:83], v[248:251], v[220:223], v[80:83]
    s_waitcnt lgkmcnt(6)
    v_mfma_f32_32x32x16_bf16 v[64:79], v[224:227], v[208:211], v[64:79]
    v_add_u32 v17, s59, v1
    v_add_u32 v18, 118784, v17
    v_mfma_f32_16x16x32_bf16 v[80:83], v[248:251], v[224:227], v[80:83]
    s_waitcnt lgkmcnt(3)
    v_mfma_f32_32x32x16_bf16 v[64:79], v[228:231], v[212:215], v[64:79]
    v_add_u32 v17, 98304, v17
    v_mfma_f32_16x16x32_bf16 v[80:83], v[248:251], v[228:231], v[80:83]
    s_waitcnt lgkmcnt(0)
    v_mfma_f32_32x32x16_bf16 v[64:79], v[232:235], v[216:219], v[64:79]
    s_add_u32 s59, s59, 106496
    v_add_u32 v19, s59, v183
    v_mfma_f32_16x16x32_bf16 v[80:83], v[248:251], v[232:235], v[80:83]
    s_nop 7
    v_cvt_pk_bf16_f32 v164, v80, v80
    v_and_b32 v155, 0xffff0000, v164
    v_sub_f32 v154, v80, v155
    v_cvt_pk_bf16_f32 v165, v154, 0
    s_nop 1
    v_mfma_f32_32x32x16_bf16 v[64:79], v[164:167], v[160:163], v[64:79]
    s_add_u32 s59, s50, s49
    s_waitcnt vmcnt(9)
    v_cmp_eq_u32 vcc, s59, v146
    v_cmp_eq_u32 s[100:101], s51, v147
    s_lshl_b32 s54, s48, 2
    s_add_u32 s54, s54, s44
    s_lshl_b32 s54, s54, 6
    s_lshl_b32 s59, s47, 1
    s_add_u32 s54, s54, s59
    s_lshl_b32 s54, s54, 10
    s_add_u32 s4, s54, 0xe000
    s_add_u32 s5, s54, 0xf000
    s_add_u32 s49, s54, 0x20f000
    s_add_u32 s60, s54, 0x20e000
    s_and_b64 vcc, vcc, s[100:101]
    s_cmp_eq_u64 vcc, -1
    s_cselect_b32 s52, 1, 0
    v_pk_mul_f32 v[64:65], v[64:65], v[156:157] op_sel:[0,1] op_sel_hi:[1,1]
    v_pk_mul_f32 v[66:67], v[66:67], v[156:157] op_sel:[0,1] op_sel_hi:[1,1]
    v_pk_mul_f32 v[68:69], v[68:69], v[156:157] op_sel:[0,1] op_sel_hi:[1,1]
    v_pk_mul_f32 v[70:71], v[70:71], v[156:157] op_sel:[0,1] op_sel_hi:[1,1]
    v_pk_mul_f32 v[72:73], v[72:73], v[156:157] op_sel:[0,1] op_sel_hi:[1,1]
    v_pk_mul_f32 v[74:75], v[74:75], v[156:157] op_sel:[0,1] op_sel_hi:[1,1]
    v_pk_mul_f32 v[76:77], v[76:77], v[156:157] op_sel:[0,1] op_sel_hi:[1,1]
    v_pk_mul_f32 v[78:79], v[78:79], v[156:157] op_sel:[0,1] op_sel_hi:[1,1]
    buffer_load_dwordx2 v[148:149], v150, s[28:31], s58 offen sc1
    v_cvt_pk_bf16_f32 v96, v64, v65
    v_cvt_pk_bf16_f32 v97, v66, v67
    v_cvt_pk_bf16_f32 v98, v68, v69
    v_cvt_pk_bf16_f32 v99, v70, v71
    v_cvt_pk_bf16_f32 v100, v72, v73
    v_cvt_pk_bf16_f32 v101, v74, v75
    v_cvt_pk_bf16_f32 v102, v76, v77
    v_cvt_pk_bf16_f32 v103, v78, v79
    ds_write_b128 v181, v[96:99]
    ds_write_b128 v181, v[100:103] offset:2048
    s_waitcnt vmcnt(0)
    v_cmp_eq_u32 vcc, s55, v148
    v_cmp_eq_u32 s[100:101], s51, v149
    s_and_b64 vcc, vcc, s[100:101]
    s_andn2_b64 s[100:101], s[56:57], vcc
    s_cselect_b32 s54, 0, 1
    s_cbranch_scc1 L_second_2
    buffer_load_dwordx4 a[28:31], v1, s[28:31], s5 offen offset:3072 sc1
    buffer_load_dwordx4 a[24:27], v1, s[28:31], s5 offen offset:2048 sc1
    buffer_load_dwordx4 a[20:23], v1, s[28:31], s5 offen offset:1024 sc1
    buffer_load_dwordx4 a[16:19], v1, s[28:31], s5 offen offset:0 sc1
    s_branch L_firstdone_3
L_second_2:
    buffer_load_dwordx2 v[148:149], v150, s[28:31], s58 offen sc1
L_firstdone_3:
    s_waitcnt lgkmcnt(0)
    s_barrier
    ds_read_b128 v[32:35], v18 offset:0
    ds_read_b128 a[32:35], v17 offset:0
    ds_read_b128 v[36:39], v18 offset:1024
    ds_read_b128 a[36:39], v17 offset:1024
    s_mov_b64 exec, s[98:99]
    ds_read_b128 a[104:107], v19 offset:0
    ds_read_b128 a[108:111], v19 offset:512
    ds_read_b128 a[112:115], v19 offset:1024
    ds_read_b128 a[116:119], v19 offset:1536
    s_mov_b64 exec, -1
    s_cmp_eq_u32 s54, 0
    s_cbranch_scc1 L_notearly_4
    buffer_load_dwordx4 a[12:15], v1, s[28:31], s4 offen offset:3072 sc1
    buffer_load_dwordx4 a[8:11], v1, s[28:31], s4 offen offset:2048 sc1
    buffer_load_dwordx4 a[4:7], v1, s[28:31], s4 offen offset:1024 sc1
    buffer_load_dwordx4 a[0:3], v1, s[28:31], s4 offen offset:0 sc1
L_notearly_4:
    ds_read_b64_tr_b16 v[192:193], v30 offset:0
    ds_read_b64_tr_b16 v[194:195], v30 offset:1024
    ds_read_b64_tr_b16 v[196:197], v31 offset:0
    ds_read_b64_tr_b16 v[198:199], v31 offset:1024
    ds_read_b64_tr_b16 v[200:201], v30 offset:2048
    ds_read_b64_tr_b16 v[202:203], v30 offset:3072
    ds_read_b64_tr_b16 v[204:205], v31 offset:2048
    ds_read_b64_tr_b16 v[206:207], v31 offset:3072
    ds_read_b64_tr_b16 v[208:209], v30 offset:4096
    ds_read_b64_tr_b16 v[210:211], v30 offset:5120
    ds_read_b64_tr_b16 v[212:213], v31 offset:4096
    ds_read_b64_tr_b16 v[214:215], v31 offset:5120
    ds_read_b64_tr_b16 v[216:217], v30 offset:6144
    ds_read_b64_tr_b16 v[218:219], v30 offset:7168
    ds_read_b64_tr_b16 v[220:221], v31 offset:6144
    ds_read_b64_tr_b16 v[222:223], v31 offset:7168
    s_waitcnt lgkmcnt(15)
    v_mfma_f32_32x32x16_bf16 v[104:119], a[32:35], v[36:39], 0
    v_mfma_f32_32x32x16_bf16 v[72:87], a[32:35], v[32:35], 0
    v_mfma_f32_32x32x16_bf16 v[88:103], a[36:39], v[36:39], 0
    s_waitcnt lgkmcnt(0)
    s_barrier
    s_cmp_eq_u32 s54, 1
    s_cbranch_scc1 L_haloearly_5
    s_min_u32 s55, s47, 4
    s_lshl_b32 s55, s55, 1
    s_lshl_b32 s56, 1, s55
    s_sub_u32 s56, s56, 1
    s_mov_b32 s57, 0
    s_add_u32 s55, s50, 15
    s_waitcnt vmcnt(0)
    v_cmp_eq_u32 vcc, s55, v148
    v_cmp_eq_u32 s[100:101], s51, v149
    s_and_b64 vcc, vcc, s[100:101]
    s_andn2_b64 s[100:101], s[56:57], vcc
    s_cbranch_scc0 L_second_ok_6
    s_mov_b32 s59, 0x40000
    s_waitcnt vmcnt(0) lgkmcnt(0)
    s_nop 7
L_poll_7:
    buffer_load_dwordx2 v[18:19], v150, s[28:31], s58 offen sc1
    s_waitcnt vmcnt(0)
    v_subrev_u32 v18, s55, v18
    v_cmp_eq_u32 vcc, s51, v19
    v_cmp_gt_u32 s[100:101], 1, v18
    s_and_b64 vcc, vcc, s[100:101]
    s_andn2_b64 s[100:101], s[56:57], vcc
    s_cbranch_scc0 L_polldone_8
    s_sub_u32 s59, s59, 1
    s_cbranch_scc1 L_pollto_9
    s_branch L_poll_7
L_pollto_9:
    v_mov_b32 v18, 256
    v_mov_b32 v19, 0
    global_store_dword v19, v18, s[6:7]
    s_waitcnt vmcnt(0)
L_polldone_8:
L_second_ok_6:
    buffer_load_dwordx4 a[28:31], v1, s[28:31], s5 offen offset:3072 sc1
    buffer_load_dwordx4 a[24:27], v1, s[28:31], s5 offen offset:2048 sc1
    buffer_load_dwordx4 a[20:23], v1, s[28:31], s5 offen offset:1024 sc1
    buffer_load_dwordx4 a[16:19], v1, s[28:31], s5 offen offset:0 sc1
    buffer_load_dwordx4 a[12:15], v1, s[28:31], s4 offen offset:3072 sc1
    buffer_load_dwordx4 a[8:11], v1, s[28:31], s4 offen offset:2048 sc1
    buffer_load_dwordx4 a[4:7], v1, s[28:31], s4 offen offset:1024 sc1
    buffer_load_dwordx4 a[0:3], v1, s[28:31], s4 offen offset:0 sc1
L_haloearly_5:
    s_nop 5
    v_max3_f32 v186, v186, v104, v105
    v_max3_f32 v187, v187, v106, v107
    v_max3_f32 v186, v186, v108, v109
    v_max3_f32 v187, v187, v110, v111
    v_max3_f32 v186, v186, v112, v113
    v_max3_f32 v187, v187, v114, v115
    v_max3_f32 v186, v186, v116, v117
    v_max3_f32 v187, v187, v118, v119
    s_mov_b64 exec, s[98:99]
    buffer_load_dwordx4 a[96:99], v183, s[28:31], s49 offen offset:3072 sc1
    buffer_load_dwordx4 a[100:103], v183, s[28:31], s49 offen offset:3584 sc1
    s_mov_b64 exec, -1
    s_waitcnt vmcnt(5)
    v_mfma_f32_32x32x16_bf16 v[120:135], a[28:31], v[32:35], 0
    v_mfma_f32_32x32x16_bf16 v[136:151], a[28:31], v[36:39], 0
    s_cmp_lt_u32 s47, 1
    s_cbranch_scc1 L_p1_short1
    s_waitcnt vmcnt(4)
    v_mfma_f32_32x32x16_bf16 v[104:119], a[24:27], v[32:35], 0
    s_nop 6
    v_max3_f32 v184, v184, v120, v121
    v_max3_f32 v185, v185, v122, v123
    v_max3_f32 v184, v184, v124, v125
    v_max3_f32 v185, v185, v126, v127
    s_add_u32 m0, s0, 131072
    s_add_u32 s3, s2, 65536
    buffer_load_dwordx4 v20, s[16:19], s3 offen lds
    v_max3_f32 v184, v184, v128, v129
    v_max3_f32 v185, v185, v130, v131
    v_max3_f32 v184, v184, v132, v133
    v_max3_f32 v185, v185, v134, v135
    v_mfma_f32_32x32x16_bf16 v[120:135], a[24:27], v[36:39], 0
    v_max3_f32 v186, v186, v136, v137
    v_max3_f32 v187, v187, v138, v139
    v_max3_f32 v186, v186, v140, v141
    v_max3_f32 v187, v187, v142, v143
    buffer_load_dwordx4 v236, s[16:19], s3 offen offset:1024 lds
    v_max3_f32 v186, v186, v144, v145
    v_max3_f32 v187, v187, v146, v147
    v_max3_f32 v186, v186, v148, v149
    v_max3_f32 v187, v187, v150, v151
    s_waitcnt vmcnt(5)
    v_mfma_f32_32x32x16_bf16 v[136:151], a[20:23], v[32:35], 0
    v_max3_f32 v184, v184, v104, v105
    v_max3_f32 v185, v185, v106, v107
    v_max3_f32 v184, v184, v108, v109
    v_max3_f32 v185, v185, v110, v111
    s_mov_b64 exec, s[98:99]
    buffer_load_dwordx4 a[88:91], v183, s[28:31], s49 offen offset:2048 sc1
    buffer_load_dwordx4 a[92:95], v183, s[28:31], s49 offen offset:2560 sc1
    s_mov_b64 exec, -1
    v_max3_f32 v184, v184, v112, v113
    v_max3_f32 v185, v185, v114, v115
    v_max3_f32 v184, v184, v116, v117
    v_max3_f32 v185, v185, v118, v119
    v_mfma_f32_32x32x16_bf16 v[104:119], a[20:23], v[36:39], 0
    v_max3_f32 v186, v186, v120, v121
    v_max3_f32 v187, v187, v122, v123
    v_max3_f32 v186, v186, v124, v125
    v_max3_f32 v187, v187, v126, v127
    buffer_load_dwordx4 v237, s[16:19], s3 offen offset:2048 lds
    v_max3_f32 v186, v186, v128, v129
    v_max3_f32 v187, v187, v130, v131
    v_max3_f32 v186, v186, v132, v133
    v_max3_f32 v187, v187, v134, v135
    s_cmp_lt_u32 s47, 2
    s_cbranch_scc1 L_p1_short2
    s_waitcnt vmcnt(7)
    v_mfma_f32_32x32x16_bf16 v[120:135], a[16:19], v[32:35], 0
    v_max3_f32 v184, v184, v136, v137
    v_max3_f32 v185, v185, v138, v139
    v_max3_f32 v184, v184, v140, v141
    v_max3_f32 v185, v185, v142, v143
    buffer_load_dwordx4 v238, s[16:19], s3 offen offset:3072 lds
    v_max3_f32 v184, v184, v144, v145
    v_max3_f32 v185, v185, v146, v147
    v_max3_f32 v184, v184, v148, v149
    v_max3_f32 v185, v185, v150, v151
    v_mfma_f32_32x32x16_bf16 v[136:151], a[16:19], v[36:39], 0
    v_max3_f32 v186, v186, v104, v105
    v_max3_f32 v187, v187, v106, v107
    v_max3_f32 v186, v186, v108, v109
    v_max3_f32 v187, v187, v110, v111
    s_add_u32 m0, s0, 135168
    s_add_u32 s3, s2, 98304
    buffer_load_dwordx4 v20, s[16:19], s3 offen lds
    v_max3_f32 v186, v186, v112, v113
    v_max3_f32 v187, v187, v114, v115
    v_max3_f32 v186, v186, v116, v117
    v_max3_f32 v187, v187, v118, v119
    v_mfma_f32_32x32x16_bf16 v[104:119], a[12:15], v[32:35], 0
    v_max3_f32 v184, v184, v120, v121
    v_max3_f32 v185, v185, v122, v123
    v_max3_f32 v184, v184, v124, v125
    v_max3_f32 v185, v185, v126, v127
    s_mov_b64 exec, s[98:99]
    buffer_load_dwordx4 a[80:83], v183, s[28:31], s49 offen offset:1024 sc1
    buffer_load_dwordx4 a[84:87], v183, s[28:31], s49 offen offset:1536 sc1
    s_mov_b64 exec, -1
    v_max3_f32 v184, v184, v128, v129
    v_max3_f32 v185, v185, v130, v131
    v_max3_f32 v184, v184, v132, v133
    v_max3_f32 v185, v185, v134, v135
    v_mfma_f32_32x32x16_bf16 v[120:135], a[12:15], v[36:39], 0
    v_max3_f32 v186, v186, v136, v137
    v_max3_f32 v187, v187, v138, v139
    v_max3_f32 v186, v186, v140, v141
    v_max3_f32 v187, v187, v142, v143
    buffer_load_dwordx4 v236, s[16:19], s3 offen offset:1024 lds
    v_max3_f32 v186, v186, v144, v145
    v_max3_f32 v187, v187, v146, v147
    v_max3_f32 v186, v186, v148, v149
    v_max3_f32 v187, v187, v150, v151
    s_cmp_lt_u32 s47, 3
    s_cbranch_scc1 L_p1_short3
    v_mfma_f32_32x32x16_bf16 v[136:151], a[8:11], v[32:35], 0
    v_max3_f32 v184, v184, v104, v105
    v_max3_f32 v185, v185, v106, v107
    v_max3_f32 v184, v184, v108, v109
    v_max3_f32 v185, v185, v110, v111
    buffer_load_dwordx4 v237, s[16:19], s3 offen offset:2048 lds
    v_max3_f32 v184, v184, v112, v113
    v_max3_f32 v185, v185, v114, v115
    v_max3_f32 v184, v184, v116, v117
    v_max3_f32 v185, v185, v118, v119
    v_mfma_f32_32x32x16_bf16 v[104:119], a[8:11], v[36:39], 0
    v_max3_f32 v186, v186, v120, v121
    v_max3_f32 v187, v187, v122, v123
    v_max3_f32 v186, v186, v124, v125
    v_max3_f32 v187, v187, v126, v127
    buffer_load_dwordx4 v238, s[16:19], s3 offen offset:3072 lds
    v_max3_f32 v186, v186, v128, v129
    v_max3_f32 v187, v187, v130, v131
    v_max3_f32 v186, v186, v132, v133
    v_max3_f32 v187, v187, v134, v135
    v_mfma_f32_32x32x16_bf16 v[120:135], a[4:7], v[32:35], 0
    v_max3_f32 v184, v184, v136, v137
    v_max3_f32 v185, v185, v138, v139
    v_max3_f32 v184, v184, v140, v141
    v_max3_f32 v185, v185, v142, v143
    s_mov_b64 exec, s[98:99]
    buffer_load_dwordx4 a[72:75], v183, s[28:31], s49 offen offset:0 sc1
    buffer_load_dwordx4 a[76:79], v183, s[28:31], s49 offen offset:512 sc1
    s_mov_b64 exec, -1
    v_max3_f32 v184, v184, v144, v145
    v_max3_f32 v185, v185, v146, v147
    v_max3_f32 v184, v184, v148, v149
    v_max3_f32 v185, v185, v150, v151
    v_mfma_f32_32x32x16_bf16 v[136:151], a[4:7], v[36:39], 0
    v_max3_f32 v186, v186, v104, v105
    v_max3_f32 v187, v187, v106, v107
    v_max3_f32 v186, v186, v108, v109
    v_max3_f32 v187, v187, v110, v111
    s_add_u32 m0, s1, 0
    s_mov_b32 s3, 0
    buffer_load_dwordx4 v21, s[20:23], s3 offen lds
    v_max3_f32 v186, v186, v112, v113
    v_max3_f32 v187, v187, v114, v115
    v_max3_f32 v186, v186, v116, v117
    v_max3_f32 v187, v187, v118, v119
    s_cmp_lt_u32 s47, 4
    s_cbranch_scc1 L_p1_short4
    v_mfma_f32_32x32x16_bf16 v[104:119], a[0:3], v[32:35], 0
    v_max3_f32 v184, v184, v120, v121
    v_max3_f32 v185, v185, v122, v123
    v_max3_f32 v184, v184, v124, v125
    v_max3_f32 v185, v185, v126, v127
    buffer_load_dwordx4 v189, s[20:23], s3 offen offset:1024 lds
    v_max3_f32 v184, v184, v128, v129
    v_max3_f32 v185, v185, v130, v131
    v_max3_f32 v184, v184, v132, v133
    v_max3_f32 v185, v185, v134, v135
    v_cndmask_b32 v88, v136, v88, s[64:65]
    v_cndmask_b32 v89, v137, v89, s[66:67]
    v_cndmask_b32 v90, v138, v90, s[68:69]
    v_cndmask_b32 v91, v139, v91, s[70:71]
    buffer_load_dwordx4 v190, s[20:23], s3 offen offset:2048 lds
    v_cndmask_b32 v92, v140, v92, s[72:73]
    v_cndmask_b32 v93, v141, v93, s[74:75]
    v_cndmask_b32 v94, v142, v94, s[76:77]
    v_cndmask_b32 v95, v143, v95, s[78:79]
    v_cndmask_b32 v96, v144, v96, s[80:81]
    v_cndmask_b32 v97, v145, v97, s[82:83]
    v_cndmask_b32 v98, v146, v98, s[84:85]
    v_cndmask_b32 v99, v147, v99, s[86:87]
    v_cndmask_b32 v100, v148, v100, s[88:89]
    v_cndmask_b32 v101, v149, v101, s[90:91]
    v_cndmask_b32 v102, v150, v102, s[92:93]
    v_cndmask_b32 v103, v151, v103, s[94:95]
    v_cndmask_b32 v72, v104, v72, s[64:65]
    v_cndmask_b32 v73, v105, v73, s[66:67]
    v_cndmask_b32 v74, v106, v74, s[68:69]
    v_cndmask_b32 v75, v107, v75, s[70:71]
    buffer_load_dwordx4 v191, s[20:23], s3 offen offset:3072 lds
    v_cndmask_b32 v76, v108, v76, s[72:73]
    v_cndmask_b32 v77, v109, v77, s[74:75]
    v_cndmask_b32 v78, v110, v78, s[76:77]
    v_cndmask_b32 v79, v111, v79, s[78:79]
    v_cndmask_b32 v80, v112, v80, s[80:81]
    v_cndmask_b32 v81, v113, v81, s[82:83]
    v_cndmask_b32 v82, v114, v82, s[84:85]
    v_cndmask_b32 v83, v115, v83, s[86:87]
    v_cndmask_b32 v84, v116, v84, s[88:89]
    v_cndmask_b32 v85, v117, v85, s[90:91]
    v_cndmask_b32 v86, v118, v86, s[92:93]
    v_cndmask_b32 v87, v119, v87, s[94:95]
    s_branch L_p1_join
L_p1_short1:
    s_add_u32 m0, s0, 131072
    s_add_u32 s3, s2, 65536
    buffer_load_dwordx4 v20, s[16:19], s3 offen lds
    buffer_load_dwordx4 v236, s[16:19], s3 offen offset:1024 lds
    s_mov_b64 exec, s[98:99]
    buffer_load_dwordx4 a[88:91], v183, s[28:31], s49 offen offset:2048 sc1
    buffer_load_dwordx4 a[92:95], v183, s[28:31], s49 offen offset:2560 sc1
    s_mov_b64 exec, -1
    buffer_load_dwordx4 v237, s[16:19], s3 offen offset:2048 lds
L_p1_short2:
    buffer_load_dwordx4 v238, s[16:19], s3 offen offset:3072 lds
    s_add_u32 m0, s0, 135168
    s_add_u32 s3, s2, 98304
    buffer_load_dwordx4 v20, s[16:19], s3 offen lds
    s_mov_b64 exec, s[98:99]
    buffer_load_dwordx4 a[80:83], v183, s[28:31], s49 offen offset:1024 sc1
    buffer_load_dwordx4 a[84:87], v183, s[28:31], s49 offen offset:1536 sc1
    s_mov_b64 exec, -1
    buffer_load_dwordx4 v236, s[16:19], s3 offen offset:1024 lds
L_p1_short3:
    buffer_load_dwordx4 v237, s[16:19], s3 offen offset:2048 lds
    buffer_load_dwordx4 v238, s[16:19], s3 offen offset:3072 lds
    s_mov_b64 exec, s[98:99]
    buffer_load_dwordx4 a[72:75], v183, s[28:31], s49 offen offset:0 sc1
    buffer_load_dwordx4 a[76:79], v183, s[28:31], s49 offen offset:512 sc1
    s_mov_b64 exec, -1
    s_add_u32 m0, s1, 0
    s_mov_b32 s3, 0
    buffer_load_dwordx4 v21, s[20:23], s3 offen lds
L_p1_short4:
    buffer_load_dwordx4 v189, s[20:23], s3 offen offset:1024 lds
    buffer_load_dwordx4 v190, s[20:23], s3 offen offset:2048 lds
    buffer_load_dwordx4 v191, s[20:23], s3 offen offset:3072 lds
    s_waitcnt vmcnt(0)
    v_cndmask_b32 v72, v188, v72, s[64:65]
    v_cndmask_b32 v73, v188, v73, s[66:67]
    v_cndmask_b32 v74, v188, v74, s[68:69]
    v_cndmask_b32 v75, v188, v75, s[70:71]
    v_cndmask_b32 v76, v188, v76, s[72:73]
    v_cndmask_b32 v77, v188, v77, s[74:75]
    v_cndmask_b32 v78, v188, v78, s[76:77]
    v_cndmask_b32 v79, v188, v79, s[78:79]
    v_cndmask_b32 v80, v188, v80, s[80:81]
    v_cndmask_b32 v81, v188, v81, s[82:83]
    v_cndmask_b32 v82, v188, v82, s[84:85]
    v_cndmask_b32 v83, v188, v83, s[86:87]
    v_cndmask_b32 v84, v188, v84, s[88:89]
    v_cndmask_b32 v85, v188, v85, s[90:91]
    v_cndmask_b32 v86, v188, v86, s[92:93]
    v_cndmask_b32 v87, v188, v87, s[94:95]
    v_cndmask_b32 v88, v188, v88, s[64:65]
    v_cndmask_b32 v89, v188, v89, s[66:67]
    v_cndmask_b32 v90, v188, v90, s[68:69]
    v_cndmask_b32 v91, v188, v91, s[70:71]
    v_cndmask_b32 v92, v188, v92, s[72:73]
    v_cndmask_b32 v93, v188, v93, s[74:75]
    v_cndmask_b32 v94, v188, v94, s[76:77]
    v_cndmask_b32 v95, v188, v95, s[78:79]
    v_cndmask_b32 v96, v188, v96, s[80:81]
    v_cndmask_b32 v97, v188, v97, s[82:83]
    v_cndmask_b32 v98, v188, v98, s[84:85]
    v_cndmask_b32 v99, v188, v99, s[86:87]
    v_cndmask_b32 v100, v188, v100, s[88:89]
    v_cndmask_b32 v101, v188, v101, s[90:91]
    v_cndmask_b32 v102, v188, v102, s[92:93]
    v_cndmask_b32 v103, v188, v103, s[94:95]
L_p1_join:
    v_max3_f32 v184, v184, v72, v73
    v_max3_f32 v186, v186, v88, v89
    v_max3_f32 v185, v185, v74, v75
    v_max3_f32 v187, v187, v90, v91
    v_max3_f32 v184, v184, v76, v77
    v_max3_f32 v186, v186, v92, v93
    v_max3_f32 v185, v185, v78, v79
    v_max3_f32 v187, v187, v94, v95
    v_max3_f32 v184, v184, v80, v81
    v_max3_f32 v186, v186, v96, v97
    v_max3_f32 v185, v185, v82, v83
    v_max3_f32 v187, v187, v98, v99
    v_max3_f32 v184, v184, v84, v85
    v_max3_f32 v186, v186, v100, v101
    v_max3_f32 v185, v185, v86, v87
    v_max3_f32 v187, v187, v102, v103
    v_max_f32 v184, v184, v185
    v_max_f32 v186, v186, v187
    v_mov_b32 v185, v184
    v_mov_b32 v187, v186
    s_nop 0
    v_permlane32_swap_b32 v184, v185
    v_permlane32_swap_b32 v186, v187
    v_max_f32 v184, v184, v185
    v_max_f32 v186, v186, v187
    v_sub_f32 v40, 0, v184
    v_sub_f32 v41, 0, v184
    v_sub_f32 v56, 0, v186
    v_sub_f32 v57, 0, v186
    v_pk_mov_b32 v[42:43], v[40:41], v[40:41] op_sel:[0,1]
    v_pk_mov_b32 v[44:45], v[40:41], v[40:41] op_sel:[0,1]
    v_pk_mov_b32 v[46:47], v[40:41], v[40:41] op_sel:[0,1]
    v_pk_mov_b32 v[48:49], v[40:41], v[40:41] op_sel:[0,1]
    v_pk_mov_b32 v[50:51], v[40:41], v[40:41] op_sel:[0,1]
    v_pk_mov_b32 v[52:53], v[40:41], v[40:41] op_sel:[0,1]
    v_pk_mov_b32 v[54:55], v[40:41], v[40:41] op_sel:[0,1]
    v_pk_mov_b32 v[58:59], v[56:57], v[56:57] op_sel:[0,1]
    v_pk_mov_b32 v[60:61], v[56:57], v[56:57] op_sel:[0,1]
    v_pk_mov_b32 v[62:63], v[56:57], v[56:57] op_sel:[0,1]
    v_pk_mov_b32 v[64:65], v[56:57], v[56:57] op_sel:[0,1]
    v_pk_mov_b32 v[66:67], v[56:57], v[56:57] op_sel:[0,1]
    v_pk_mov_b32 v[68:69], v[56:57], v[56:57] op_sel:[0,1]
    v_pk_mov_b32 v[70:71], v[56:57], v[56:57] op_sel:[0,1]
    v_pk_add_f32 v[72:73], v[72:73], v[40:41]
    v_pk_add_f32 v[74:75], v[74:75], v[40:41]
    v_pk_add_f32 v[76:77], v[76:77], v[40:41]
    v_pk_add_f32 v[78:79], v[78:79], v[40:41]
    v_pk_add_f32 v[80:81], v[80:81], v[40:41]
    v_pk_add_f32 v[82:83], v[82:83], v[40:41]
    v_pk_add_f32 v[84:85], v[84:85], v[40:41]
    v_pk_add_f32 v[86:87], v[86:87], v[40:41]
    v_pk_add_f32 v[88:89], v[88:89], v[56:57]
    v_pk_add_f32 v[90:91], v[90:91], v[56:57]
    v_pk_add_f32 v[92:93], v[92:93], v[56:57]
    v_pk_add_f32 v[94:95], v[94:95], v[56:57]
    v_pk_add_f32 v[96:97], v[96:97], v[56:57]
    v_pk_add_f32 v[98:99], v[98:99], v[56:57]
    v_pk_add_f32 v[100:101], v[100:101], v[56:57]
    v_pk_add_f32 v[102:103], v[102:103], v[56:57]
    v_exp_f32 v72, v72
    v_mfma_f32_32x32x16_bf16 v[104:119], a[32:35], v[36:39], v[56:71]
    v_exp_f32 v73, v73
    v_exp_f32 v74, v74
    v_exp_f32 v75, v75
    v_cvt_pk_bf16_f32 v72, v72, v73
    v_exp_f32 v76, v76
    v_mfma_f32_32x32x16_bf16 v[120:135], a[28:31], v[32:35], v[40:55]
    v_exp_f32 v77, v77
    v_cvt_pk_bf16_f32 v73, v74, v75
    v_exp_f32 v78, v78
    v_exp_f32 v79, v79
    v_cvt_pk_bf16_f32 v74, v76, v77
    v_exp_f32 v80, v80
    s_mov_b64 exec, s[98:99]
    buffer_load_dwordx4 a[64:67], v183, s[28:31], s60 offen offset:3072 sc1
    buffer_load_dwordx4 a[68:71], v183, s[28:31], s60 offen offset:3584 sc1
    s_mov_b64 exec, -1
    v_exp_f32 v81, v81
    v_cvt_pk_bf16_f32 v75, v78, v79
    v_exp_f32 v82, v82
    v_exp_f32 v83, v83
    v_cvt_pk_bf16_f32 v76, v80, v81
    v_exp_f32 v84, v84
    v_exp_f32 v85, v85
    v_cvt_pk_bf16_f32 v77, v82, v83
    s_mov_b64 exec, s[98:99]
    buffer_load_dwordx4 a[56:59], v183, s[28:31], s60 offen offset:2048 sc1
    buffer_load_dwordx4 a[60:63], v183, s[28:31], s60 offen offset:2560 sc1
    s_mov_b64 exec, -1
    v_exp_f32 v86, v86
    v_exp_f32 v87, v87
    v_cvt_pk_bf16_f32 v78, v84, v85
    v_cvt_pk_bf16_f32 v79, v86, v87
    v_and_b32 v80, v72, v22
    v_and_b32 v81, v73, v23
    v_and_b32 v82, v74, v24
    v_and_b32 v83, v75, v25
    v_and_b32 v84, v76, v26
    s_waitcnt vmcnt(10)
    ds_read_b64_tr_b16 v[224:225], v30 offset:0
    ds_read_b64_tr_b16 v[226:227], v30 offset:1024
    ds_read_b64_tr_b16 v[228:229], v31 offset:0
    ds_read_b64_tr_b16 v[230:231], v31 offset:1024
    v_and_b32 v85, v77, v27
    v_and_b32 v86, v78, v28
    v_and_b32 v87, v79, v29
    v_xor_b32 v72, v72, v80
    v_xor_b32 v73, v73, v81
    v_xor_b32 v74, v74, v82
    v_xor_b32 v75, v75, v83
    v_xor_b32 v76, v76, v84
    v_xor_b32 v77, v77, v85
    v_xor_b32 v78, v78, v86
    v_xor_b32 v79, v79, v87
    v_exp_f32 v88, v88
    v_exp_f32 v89, v89
    v_mfma_f32_32x32x16_bf16 v[152:167], a[104:107], v[80:83], 0
    v_exp_f32 v90, v90
    v_exp_f32 v91, v91
    v_cvt_pk_bf16_f32 v88, v88, v89
    v_exp_f32 v92, v92
    v_exp_f32 v93, v93
    v_mfma_f32_32x32x16_bf16 v[152:167], a[108:111], v[84:87], v[152:167]
    v_cvt_pk_bf16_f32 v89, v90, v91
    v_exp_f32 v94, v94
    v_exp_f32 v95, v95
    v_cvt_pk_bf16_f32 v90, v92, v93
    v_exp_f32 v96, v96
    s_mov_b64 exec, s[98:99]
    buffer_load_dwordx4 a[48:51], v183, s[28:31], s60 offen offset:1024 sc1
    buffer_load_dwordx4 a[52:55], v183, s[28:31], s60 offen offset:1536 sc1
    s_mov_b64 exec, -1
    v_exp_f32 v97, v97
    v_cvt_pk_bf16_f32 v91, v94, v95
    v_exp_f32 v98, v98
    v_exp_f32 v99, v99
    v_cvt_pk_bf16_f32 v92, v96, v97
    v_exp_f32 v100, v100
    v_exp_f32 v101, v101
    v_cvt_pk_bf16_f32 v93, v98, v99
    ds_read_b64_tr_b16 v[232:233], v30 offset:2048
    ds_read_b64_tr_b16 v[234:235], v30 offset:3072
    ds_read_b64_tr_b16 v[236:237], v31 offset:2048
    ds_read_b64_tr_b16 v[238:239], v31 offset:3072
    v_exp_f32 v102, v102
    v_exp_f32 v103, v103
    v_cvt_pk_bf16_f32 v94, v100, v101
    v_cvt_pk_bf16_f32 v95, v102, v103
    v_and_b32 v96, v88, v22
    v_and_b32 v97, v89, v23
    v_and_b32 v98, v90, v24
    v_and_b32 v99, v91, v25
    v_and_b32 v100, v92, v26
    s_mov_b64 exec, s[98:99]
    buffer_load_dwordx4 a[40:43], v183, s[28:31], s60 offen offset:0 sc1
    buffer_load_dwordx4 a[44:47], v183, s[28:31], s60 offen offset:512 sc1
    s_mov_b64 exec, -1
    v_and_b32 v101, v93, v27
    v_and_b32 v102, v94, v28
    v_and_b32 v103, v95, v29
    v_xor_b32 v88, v88, v96
    v_xor_b32 v89, v89, v97
    v_xor_b32 v90, v90, v98
    v_xor_b32 v91, v91, v99
    v_xor_b32 v92, v92, v100
    v_xor_b32 v93, v93, v101
    v_xor_b32 v94, v94, v102
    v_xor_b32 v95, v95, v103
    v_exp_f32 v104, v104
    v_exp_f32 v105, v105
    v_mfma_f32_32x32x16_bf16 v[168:183], a[112:115], v[96:99], 0
    v_exp_f32 v106, v106
    v_exp_f32 v107, v107
    ds_read_b64_tr_b16 v[240:241], v30 offset:4096
    ds_read_b64_tr_b16 v[242:243], v30 offset:5120
    ds_read_b64_tr_b16 v[244:245], v31 offset:4096
    ds_read_b64_tr_b16 v[246:247], v31 offset:5120
    v_cvt_pk_bf16_f32 v104, v104, v105
    v_exp_f32 v108, v108
    v_exp_f32 v109, v109
    v_mfma_f32_32x32x16_bf16 v[168:183], a[116:119], v[100:103], v[168:183]
    v_cvt_pk_bf16_f32 v105, v106, v107
    v_exp_f32 v110, v110
    v_exp_f32 v111, v111
    ds_read_b64_tr_b16 v[248:249], v30 offset:6144
    ds_read_b64_tr_b16 v[250:251], v30 offset:7168
    ds_read_b64_tr_b16 v[252:253], v31 offset:6144
    ds_read_b64_tr_b16 v[254:255], v31 offset:7168
    v_cvt_pk_bf16_f32 v106, v108, v109
    v_exp_f32 v112, v112
    v_exp_f32 v113, v113
    v_mfma_f32_32x32x16_bf16 v[136:151], a[28:31], v[36:39], v[56:71]
    v_cvt_pk_bf16_f32 v107, v110, v111
    v_exp_f32 v114, v114
    v_exp_f32 v115, v115
    s_add_u32 m0, s1, 16384
    s_mov_b32 s3, 229376
    buffer_load_dwordx4 v21, s[20:23], s3 offen lds
    v_cvt_pk_bf16_f32 v108, v112, v113
    v_exp_f32 v116, v116
    v_exp_f32 v117, v117
    v_cvt_pk_bf16_f32 v109, v114, v115
    v_exp_f32 v118, v118
    v_exp_f32 v119, v119
    buffer_load_dwordx4 v189, s[20:23], s3 offen offset:1024 lds
    v_cvt_pk_bf16_f32 v110, v116, v117
    v_cvt_pk_bf16_f32 v111, v118, v119
    v_mfma_f32_32x32x16_bf16 v[168:183], a[104:107], v[104:107], v[168:183]
    s_nop 0
    v_mfma_f32_32x32x16_bf16 v[168:183], a[108:111], v[108:111], v[168:183]
    s_cmp_lt_u32 s47, 1
    s_cbranch_scc1 L_p2_short1
    v_exp_f32 v120, v120
    v_exp_f32 v121, v121
    v_exp_f32 v122, v122
    v_exp_f32 v123, v123
    buffer_load_dwordx4 v190, s[20:23], s3 offen offset:2048 lds
    v_cvt_pk_bf16_f32 v120, v120, v121
    v_exp_f32 v124, v124
    v_exp_f32 v125, v125
    v_cvt_pk_bf16_f32 v121, v122, v123
    v_exp_f32 v126, v126
    v_exp_f32 v127, v127
    buffer_load_dwordx4 v191, s[20:23], s3 offen offset:3072 lds
    v_cvt_pk_bf16_f32 v122, v124, v125
    v_exp_f32 v128, v128
    v_exp_f32 v129, v129
    v_mfma_f32_32x32x16_bf16 v[104:119], a[24:27], v[32:35], v[40:55]
    v_cvt_pk_bf16_f32 v123, v126, v127
    v_exp_f32 v130, v130
    v_exp_f32 v131, v131
    s_add_u32 m0, s1, 32768
    s_mov_b32 s3, 458752
    buffer_load_dwordx4 v21, s[20:23], s3 offen lds
    v_cvt_pk_bf16_f32 v124, v128, v129
    v_exp_f32 v132, v132
    v_exp_f32 v133, v133
    v_cvt_pk_bf16_f32 v125, v130, v131
    v_exp_f32 v134, v134
    v_exp_f32 v135, v135
    buffer_load_dwordx4 v189, s[20:23], s3 offen offset:1024 lds
    v_cvt_pk_bf16_f32 v126, v132, v133
    v_cvt_pk_bf16_f32 v127, v134, v135
    v_exp_f32 v136, v136
    v_exp_f32 v137, v137
    v_mfma_f32_32x32x16_bf16 v[152:167], a[96:99], v[120:123], v[152:167]
    v_exp_f32 v138, v138
    v_exp_f32 v139, v139
    buffer_load_dwordx4 v190, s[20:23], s3 offen offset:2048 lds
    v_cvt_pk_bf16_f32 v136, v136, v137
    v_exp_f32 v140, v140
    v_exp_f32 v141, v141
    v_mfma_f32_32x32x16_bf16 v[152:167], a[100:103], v[124:127], v[152:167]
    v_cvt_pk_bf16_f32 v137, v138, v139
    v_exp_f32 v142, v142
    v_exp_f32 v143, v143
    buffer_load_dwordx4 v191, s[20:23], s3 offen offset:3072 lds
    v_cvt_pk_bf16_f32 v138, v140, v141
    v_exp_f32 v144, v144
    v_exp_f32 v145, v145
    v_mfma_f32_32x32x16_bf16 v[120:135], a[24:27], v[36:39], v[56:71]
    v_cvt_pk_bf16_f32 v139, v142, v143
    v_exp_f32 v146, v146
    v_exp_f32 v147, v147
    v_cvt_pk_bf16_f32 v140, v144, v145
    v_exp_f32 v148, v148
    s_add_u32 m0, s1, 49152
    s_mov_b32 s3, 688128
    buffer_load_dwordx4 v21, s[20:23], s3 offen lds
    v_exp_f32 v149, v149
    v_cvt_pk_bf16_f32 v141, v146, v147
    v_exp_f32 v150, v150
    v_exp_f32 v151, v151
    v_cvt_pk_bf16_f32 v142, v148, v149
    v_cvt_pk_bf16_f32 v143, v150, v151
    v_exp_f32 v104, v104
    v_exp_f32 v105, v105
    v_mfma_f32_32x32x16_bf16 v[168:183], a[96:99], v[136:139], v[168:183]
    v_exp_f32 v106, v106
    v_exp_f32 v107, v107
    buffer_load_dwordx4 v189, s[20:23], s3 offen offset:1024 lds
    v_cvt_pk_bf16_f32 v104, v104, v105
    v_exp_f32 v108, v108
    v_exp_f32 v109, v109
    v_mfma_f32_32x32x16_bf16 v[168:183], a[100:103], v[140:143], v[168:183]
    v_cvt_pk_bf16_f32 v105, v106, v107
    v_exp_f32 v110, v110
    v_exp_f32 v111, v111
    buffer_load_dwordx4 v190, s[20:23], s3 offen offset:2048 lds
    v_cvt_pk_bf16_f32 v106, v108, v109
    v_exp_f32 v112, v112
    v_exp_f32 v113, v113
    v_mfma_f32_32x32x16_bf16 v[136:151], a[20:23], v[32:35], v[40:55]
    v_cvt_pk_bf16_f32 v107, v110, v111
    v_exp_f32 v114, v114
    v_exp_f32 v115, v115
    v_cvt_pk_bf16_f32 v108, v112, v113
    v_exp_f32 v116, v116
    buffer_load_dwordx4 v191, s[20:23], s3 offen offset:3072 lds
    v_exp_f32 v117, v117
    v_cvt_pk_bf16_f32 v109, v114, v115
    v_exp_f32 v118, v118
    v_exp_f32 v119, v119
    v_cvt_pk_bf16_f32 v110, v116, v117
    v_cvt_pk_bf16_f32 v111, v118, v119
    v_exp_f32 v120, v120
    v_exp_f32 v121, v121
    v_mfma_f32_32x32x16_bf16 v[152:167], a[88:91], v[104:107], v[152:167]
    v_exp_f32 v122, v122
    v_exp_f32 v123, v123
    s_add_u32 m0, s1, 65536
    s_mov_b32 s3, 917504
    buffer_load_dwordx4 v21, s[20:23], s3 offen lds
    v_cvt_pk_bf16_f32 v120, v120, v121
    v_exp_f32 v124, v124
    v_exp_f32 v125, v125
    v_mfma_f32_32x32x16_bf16 v[152:167], a[92:95], v[108:111], v[152:167]
    v_cvt_pk_bf16_f32 v121, v122, v123
    v_exp_f32 v126, v126
    v_exp_f32 v127, v127
    buffer_load_dwordx4 v189, s[20:23], s3 offen offset:1024 lds
    v_cvt_pk_bf16_f32 v122, v124, v125
    v_exp_f32 v128, v128
    v_exp_f32 v129, v129
    v_mfma_f32_32x32x16_bf16 v[104:119], a[20:23], v[36:39], v[56:71]
    v_cvt_pk_bf16_f32 v123, v126, v127
    v_exp_f32 v130, v130
    v_exp_f32 v131, v131
    v_cvt_pk_bf16_f32 v124, v128, v129
    v_exp_f32 v132, v132
    buffer_load_dwordx4 v190, s[20:23], s3 offen offset:2048 lds
    v_exp_f32 v133, v133
    v_cvt_pk_bf16_f32 v125, v130, v131
    v_exp_f32 v134, v134
    v_exp_f32 v135, v135
    v_cvt_pk_bf16_f32 v126, v132, v133
    v_cvt_pk_bf16_f32 v127, v134, v135
    v_mfma_f32_32x32x16_bf16 v[168:183], a[88:91], v[120:123], v[168:183]
    s_nop 0
    v_mfma_f32_32x32x16_bf16 v[168:183], a[92:95], v[124:127], v[168:183]
    s_cmp_lt_u32 s47, 2
    s_cbranch_scc1 L_p2_short2
    v_exp_f32 v136, v136
    v_exp_f32 v137, v137
    v_exp_f32 v138, v138
    v_exp_f32 v139, v139
    buffer_load_dwordx4 v191, s[20:23], s3 offen offset:3072 lds
    v_cvt_pk_bf16_f32 v136, v136, v137
    v_exp_f32 v140, v140
    v_exp_f32 v141, v141
    v_cvt_pk_bf16_f32 v137, v138, v139
    v_exp_f32 v142, v142
    v_exp_f32 v143, v143
    s_add_u32 m0, s1, 81920
    s_mov_b32 s3, 1146880
    buffer_load_dwordx4 v21, s[20:23], s3 offen lds
    v_cvt_pk_bf16_f32 v138, v140, v141
    v_exp_f32 v144, v144
    v_exp_f32 v145, v145
    v_mfma_f32_32x32x16_bf16 v[120:135], a[16:19], v[32:35], v[40:55]
    v_cvt_pk_bf16_f32 v139, v142, v143
    v_exp_f32 v146, v146
    v_exp_f32 v147, v147
    v_cvt_pk_bf16_f32 v140, v144, v145
    v_exp_f32 v148, v148
    buffer_load_dwordx4 v189, s[20:23], s3 offen offset:1024 lds
    v_exp_f32 v149, v149
    v_cvt_pk_bf16_f32 v141, v146, v147
    v_exp_f32 v150, v150
    v_exp_f32 v151, v151
    v_cvt_pk_bf16_f32 v142, v148, v149
    v_cvt_pk_bf16_f32 v143, v150, v151
    v_exp_f32 v104, v104
    v_exp_f32 v105, v105
    v_mfma_f32_32x32x16_bf16 v[152:167], a[80:83], v[136:139], v[152:167]
    v_exp_f32 v106, v106
    v_exp_f32 v107, v107
    buffer_load_dwordx4 v190, s[20:23], s3 offen offset:2048 lds
    v_cvt_pk_bf16_f32 v104, v104, v105
    v_exp_f32 v108, v108
    v_exp_f32 v109, v109
    v_mfma_f32_32x32x16_bf16 v[152:167], a[84:87], v[140:143], v[152:167]
    v_cvt_pk_bf16_f32 v105, v106, v107
    v_exp_f32 v110, v110
    v_exp_f32 v111, v111
    buffer_load_dwordx4 v191, s[20:23], s3 offen offset:3072 lds
    v_cvt_pk_bf16_f32 v106, v108, v109
    v_exp_f32 v112, v112
    v_exp_f32 v113, v113
    v_mfma_f32_32x32x16_bf16 v[136:151], a[16:19], v[36:39], v[56:71]
    v_cvt_pk_bf16_f32 v107, v110, v111
    v_exp_f32 v114, v114
    v_exp_f32 v115, v115
    v_cvt_pk_bf16_f32 v108, v112, v113
    v_exp_f32 v116, v116
    s_add_u32 m0, s1, 98304
    s_mov_b32 s3, 1376256
    buffer_load_dwordx4 v21, s[20:23], s3 offen lds
    v_exp_f32 v117, v117
    v_cvt_pk_bf16_f32 v109, v114, v115
    v_exp_f32 v118, v118
    v_exp_f32 v119, v119
    v_cvt_pk_bf16_f32 v110, v116, v117
    v_cvt_pk_bf16_f32 v111, v118, v119
    v_exp_f32 v120, v120
    v_exp_f32 v121, v121
    v_mfma_f32_32x32x16_bf16 v[168:183], a[80:83], v[104:107], v[168:183]
    v_exp_f32 v122, v122
    v_exp_f32 v123, v123
    buffer_load_dwordx4 v189, s[20:23], s3 offen offset:1024 lds
    v_cvt_pk_bf16_f32 v120, v120, v121
    v_exp_f32 v124, v124
    v_exp_f32 v125, v125
    v_mfma_f32_32x32x16_bf16 v[168:183], a[84:87], v[108:111], v[168:183]
    v_cvt_pk_bf16_f32 v121, v122, v123
    v_exp_f32 v126, v126
    v_exp_f32 v127, v127
    buffer_load_dwordx4 v190, s[20:23], s3 offen offset:2048 lds
    v_cvt_pk_bf16_f32 v122, v124, v125
    v_exp_f32 v128, v128
    v_exp_f32 v129, v129
    v_mfma_f32_32x32x16_bf16 v[104:119], a[12:15], v[32:35], v[40:55]
    v_cvt_pk_bf16_f32 v123, v126, v127
    v_exp_f32 v130, v130
    v_exp_f32 v131, v131
    v_cvt_pk_bf16_f32 v124, v128, v129
    v_exp_f32 v132, v132
    buffer_load_dwordx4 v191, s[20:23], s3 offen offset:3072 lds
    v_exp_f32 v133, v133
    v_cvt_pk_bf16_f32 v125, v130, v131
    v_exp_f32 v134, v134
    v_exp_f32 v135, v135
    v_cvt_pk_bf16_f32 v126, v132, v133
    v_cvt_pk_bf16_f32 v127, v134, v135
    v_exp_f32 v136, v136
    v_exp_f32 v137, v137
    s_waitcnt vmcnt(37)
    v_mfma_f32_32x32x16_bf16 v[152:167], a[72:75], v[120:123], v[152:167]
    v_exp_f32 v138, v138
    v_exp_f32 v139, v139
    s_add_u32 m0, s1, 114688
    s_mov_b32 s3, 1605632
    buffer_load_dwordx4 v21, s[20:23], s3 offen lds
    v_cvt_pk_bf16_f32 v136, v136, v137
    v_exp_f32 v140, v140
    v_exp_f32 v141, v141
    s_waitcnt vmcnt(37)
    v_mfma_f32_32x32x16_bf16 v[152:167], a[76:79], v[124:127], v[152:167]
    v_cvt_pk_bf16_f32 v137, v138, v139
    v_exp_f32 v142, v142
    v_exp_f32 v143, v143
    buffer_load_dwordx4 v189, s[20:23], s3 offen offset:1024 lds
    v_cvt_pk_bf16_f32 v138, v140, v141
    v_exp_f32 v144, v144
    v_exp_f32 v145, v145
    v_mfma_f32_32x32x16_bf16 v[120:135], a[12:15], v[36:39], v[56:71]
    v_cvt_pk_bf16_f32 v139, v142, v143
    v_exp_f32 v146, v146
    v_exp_f32 v147, v147
    v_cvt_pk_bf16_f32 v140, v144, v145
    v_exp_f32 v148, v148
    buffer_load_dwordx4 v190, s[20:23], s3 offen offset:2048 lds
    v_exp_f32 v149, v149
    v_cvt_pk_bf16_f32 v141, v146, v147
    v_exp_f32 v150, v150
    v_exp_f32 v151, v151
    v_cvt_pk_bf16_f32 v142, v148, v149
    v_cvt_pk_bf16_f32 v143, v150, v151
    v_mfma_f32_32x32x16_bf16 v[168:183], a[72:75], v[136:139], v[168:183]
    s_nop 0
    v_mfma_f32_32x32x16_bf16 v[168:183], a[76:79], v[140:143], v[168:183]
    s_cmp_lt_u32 s47, 3
    s_cbranch_scc1 L_p2_short3
    v_exp_f32 v104, v104
    v_exp_f32 v105, v105
    v_exp_f32 v106, v106
    v_exp_f32 v107, v107
    buffer_load_dwordx4 v191, s[20:23], s3 offen offset:3072 lds
    v_cvt_pk_bf16_f32 v104, v104, v105
    v_exp_f32 v108, v108
    v_exp_f32 v109, v109
    v_cvt_pk_bf16_f32 v105, v106, v107
    v_exp_f32 v110, v110
    v_exp_f32 v111, v111
    s_waitcnt lgkmcnt(0)
    s_mul_i32 s2, s44, 458752
    v_accvgpr_write_b32 a255, v20
    s_cmp_eq_u32 s48, 3
    s_cselect_b32 s56, 0, -1
    v_and_b32 v20, s56, v20
    v_add_u32 v15, 7168, v20
    v_add_u32 v14, 14336, v20
    v_add_u32 v19, 21504, v20
    s_add_u32 m0, s0, 131072
    s_add_u32 s3, s2, 0
    buffer_load_dwordx4 v20, s[24:27], s3 offen lds
    v_cvt_pk_bf16_f32 v106, v108, v109
    v_exp_f32 v112, v112
    v_exp_f32 v113, v113
    v_mfma_f32_32x32x16_bf16 v[136:151], a[8:11], v[32:35], v[40:55]
    v_cvt_pk_bf16_f32 v107, v110, v111
    v_exp_f32 v114, v114
    v_exp_f32 v115, v115
    v_cvt_pk_bf16_f32 v108, v112, v113
    v_exp_f32 v116, v116
    buffer_load_dwordx4 v15, s[24:27], s3 offen offset:1024 lds
    v_exp_f32 v117, v117
    v_cvt_pk_bf16_f32 v109, v114, v115
    v_exp_f32 v118, v118
    v_exp_f32 v119, v119
    v_cvt_pk_bf16_f32 v110, v116, v117
    v_cvt_pk_bf16_f32 v111, v118, v119
    v_exp_f32 v120, v120
    v_exp_f32 v121, v121
    s_waitcnt vmcnt(37)
    v_mfma_f32_32x32x16_bf16 v[152:167], a[64:67], v[104:107], v[152:167]
    v_exp_f32 v122, v122
    v_exp_f32 v123, v123
    buffer_load_dwordx4 v14, s[24:27], s3 offen offset:2048 lds
    v_cvt_pk_bf16_f32 v120, v120, v121
    v_exp_f32 v124, v124
    v_exp_f32 v125, v125
    s_waitcnt vmcnt(37)
    v_mfma_f32_32x32x16_bf16 v[152:167], a[68:71], v[108:111], v[152:167]
    v_cvt_pk_bf16_f32 v121, v122, v123
    v_exp_f32 v126, v126
    v_exp_f32 v127, v127
    buffer_load_dwordx4 v19, s[24:27], s3 offen offset:3072 lds
    v_cvt_pk_bf16_f32 v122, v124, v125
    v_exp_f32 v128, v128
    v_exp_f32 v129, v129
    v_mfma_f32_32x32x16_bf16 v[104:119], a[8:11], v[36:39], v[56:71]
    v_cvt_pk_bf16_f32 v123, v126, v127
    v_exp_f32 v130, v130
    v_exp_f32 v131, v131
    v_cvt_pk_bf16_f32 v124, v128, v129
    v_exp_f32 v132, v132
    s_add_u32 m0, s0, 135168
    s_add_u32 s3, s2, 32768
    buffer_load_dwordx4 v20, s[24:27], s3 offen lds
    v_exp_f32 v133, v133
    v_cvt_pk_bf16_f32 v125, v130, v131
    v_exp_f32 v134, v134
    v_exp_f32 v135, v135
    v_cvt_pk_bf16_f32 v126, v132, v133
    v_cvt_pk_bf16_f32 v127, v134, v135
    v_exp_f32 v136, v136
    v_exp_f32 v137, v137
    v_mfma_f32_32x32x16_bf16 v[168:183], a[64:67], v[120:123], v[168:183]
    v_exp_f32 v138, v138
    v_exp_f32 v139, v139
    buffer_load_dwordx4 v15, s[24:27], s3 offen offset:1024 lds
    v_cvt_pk_bf16_f32 v136, v136, v137
    v_exp_f32 v140, v140
    v_exp_f32 v141, v141
    v_mfma_f32_32x32x16_bf16 v[168:183], a[68:71], v[124:127], v[168:183]
    v_cvt_pk_bf16_f32 v137, v138, v139
    v_exp_f32 v142, v142
    v_exp_f32 v143, v143
    v_cvt_pk_bf16_f32 v138, v140, v141
    v_exp_f32 v144, v144
    v_exp_f32 v145, v145
    v_mfma_f32_32x32x16_bf16 v[120:135], a[4:7], v[32:35], v[40:55]
    v_cvt_pk_bf16_f32 v139, v142, v143
    v_exp_f32 v146, v146
    v_exp_f32 v147, v147
    v_cvt_pk_bf16_f32 v140, v144, v145
    v_exp_f32 v148, v148
    v_exp_f32 v149, v149
    v_cvt_pk_bf16_f32 v141, v146, v147
    v_exp_f32 v150, v150
    v_exp_f32 v151, v151
    v_cvt_pk_bf16_f32 v142, v148, v149
    v_cvt_pk_bf16_f32 v143, v150, v151
    v_exp_f32 v104, v104
    v_exp_f32 v105, v105
    s_waitcnt vmcnt(39)
    v_mfma_f32_32x32x16_bf16 v[152:167], a[56:59], v[136:139], v[152:167]
    v_exp_f32 v106, v106
    v_exp_f32 v107, v107
    v_cvt_pk_bf16_f32 v104, v104, v105
    v_exp_f32 v108, v108
    v_exp_f32 v109, v109
    s_waitcnt vmcnt(38)
    v_mfma_f32_32x32x16_bf16 v[152:167], a[60:63], v[140:143], v[152:167]
    v_cvt_pk_bf16_f32 v105, v106, v107
    v_exp_f32 v110, v110
    v_exp_f32 v111, v111
    v_cvt_pk_bf16_f32 v106, v108, v109
    v_exp_f32 v112, v112
    v_exp_f32 v113, v113
    v_cvt_pk_bf16_f32 v107, v110, v111
    v_exp_f32 v114, v114
    v_exp_f32 v115, v115
    v_cvt_pk_bf16_f32 v108, v112, v113
    v_exp_f32 v116, v116
    v_exp_f32 v117, v117
    v_cvt_pk_bf16_f32 v109, v114, v115
    v_exp_f32 v118, v118
    v_exp_f32 v119, v119
    v_cvt_pk_bf16_f32 v110, v116, v117
    v_cvt_pk_bf16_f32 v111, v118, v119
    v_mfma_f32_32x32x16_bf16 v[168:183], a[56:59], v[104:107], v[168:183]
    s_nop 0
    v_mfma_f32_32x32x16_bf16 v[168:183], a[60:63], v[108:111], v[168:183]
    s_cmp_lt_u32 s47, 4
    s_cbranch_scc1 L_p2_short4
    v_exp_f32 v120, v120
    v_exp_f32 v121, v121
    v_exp_f32 v122, v122
    v_exp_f32 v123, v123
    v_cvt_pk_bf16_f32 v120, v120, v121
    v_exp_f32 v124, v124
    v_exp_f32 v125, v125
    v_cvt_pk_bf16_f32 v121, v122, v123
    v_exp_f32 v126, v126
    v_exp_f32 v127, v127
    v_cvt_pk_bf16_f32 v122, v124, v125
    v_exp_f32 v128, v128
    s_waitcnt vmcnt(35)
    v_mfma_f32_32x32x16_bf16 v[152:167], a[40:43], v[72:75], v[152:167]
    v_exp_f32 v129, v129
    v_cvt_pk_bf16_f32 v123, v126, v127
    v_exp_f32 v130, v130
    s_waitcnt vmcnt(34)
    v_mfma_f32_32x32x16_bf16 v[152:167], a[44:47], v[76:79], v[152:167]
    v_exp_f32 v131, v131
    v_cvt_pk_bf16_f32 v124, v128, v129
    v_exp_f32 v132, v132
    v_mfma_f32_32x32x16_bf16 v[168:183], a[48:51], v[88:91], v[168:183]
    v_exp_f32 v133, v133
    v_cvt_pk_bf16_f32 v125, v130, v131
    v_exp_f32 v134, v134
    v_mfma_f32_32x32x16_bf16 v[168:183], a[52:55], v[92:95], v[168:183]
    v_exp_f32 v135, v135
    v_cvt_pk_bf16_f32 v126, v132, v133
    v_cvt_pk_bf16_f32 v127, v134, v135
    v_mfma_f32_32x32x16_bf16 v[152:167], a[48:51], v[120:123], v[152:167]
    s_nop 0
    v_mfma_f32_32x32x16_bf16 v[152:167], a[52:55], v[124:127], v[152:167]
    s_branch L_p2_done
L_p2_short1:
    buffer_load_dwordx4 v190, s[20:23], s3 offen offset:2048 lds
    buffer_load_dwordx4 v191, s[20:23], s3 offen offset:3072 lds
    s_add_u32 m0, s1, 32768
    s_mov_b32 s3, 458752
    buffer_load_dwordx4 v21, s[20:23], s3 offen lds
    buffer_load_dwordx4 v189, s[20:23], s3 offen offset:1024 lds
    buffer_load_dwordx4 v190, s[20:23], s3 offen offset:2048 lds
    buffer_load_dwordx4 v191, s[20:23], s3 offen offset:3072 lds
    s_add_u32 m0, s1, 49152
    s_mov_b32 s3, 688128
    buffer_load_dwordx4 v21, s[20:23], s3 offen lds
    buffer_load_dwordx4 v189, s[20:23], s3 offen offset:1024 lds
    buffer_load_dwordx4 v190, s[20:23], s3 offen offset:2048 lds
    buffer_load_dwordx4 v191, s[20:23], s3 offen offset:3072 lds
    s_add_u32 m0, s1, 65536
    s_mov_b32 s3, 917504
    buffer_load_dwordx4 v21, s[20:23], s3 offen lds
    buffer_load_dwordx4 v189, s[20:23], s3 offen offset:1024 lds
    buffer_load_dwordx4 v190, s[20:23], s3 offen offset:2048 lds
L_p2_short2:
    buffer_load_dwordx4 v191, s[20:23], s3 offen offset:3072 lds
    s_add_u32 m0, s1, 81920
    s_mov_b32 s3, 1146880
    buffer_load_dwordx4 v21, s[20:23], s3 offen lds
    buffer_load_dwordx4 v189, s[20:23], s3 offen offset:1024 lds
    buffer_load_dwordx4 v190, s[20:23], s3 offen offset:2048 lds
    buffer_load_dwordx4 v191, s[20:23], s3 offen offset:3072 lds
    s_add_u32 m0, s1, 98304
    s_mov_b32 s3, 1376256
    buffer_load_dwordx4 v21, s[20:23], s3 offen lds
    buffer_load_dwordx4 v189, s[20:23], s3 offen offset:1024 lds
    buffer_load_dwordx4 v190, s[20:23], s3 offen offset:2048 lds
    buffer_load_dwordx4 v191, s[20:23], s3 offen offset:3072 lds
    s_add_u32 m0, s1, 114688
    s_mov_b32 s3, 1605632
    buffer_load_dwordx4 v21, s[20:23], s3 offen lds
    buffer_load_dwordx4 v189, s[20:23], s3 offen offset:1024 lds
    buffer_load_dwordx4 v190, s[20:23], s3 offen offset:2048 lds
L_p2_short3:
    buffer_load_dwordx4 v191, s[20:23], s3 offen offset:3072 lds
    s_waitcnt lgkmcnt(0)
    s_mul_i32 s2, s44, 458752
    v_accvgpr_write_b32 a255, v20
    s_cmp_eq_u32 s48, 3
    s_cselect_b32 s56, 0, -1
    v_and_b32 v20, s56, v20
    v_add_u32 v15, 7168, v20
    v_add_u32 v14, 14336, v20
    v_add_u32 v19, 21504, v20
    s_add_u32 m0, s0, 131072
    s_add_u32 s3, s2, 0
    buffer_load_dwordx4 v20, s[24:27], s3 offen lds
    buffer_load_dwordx4 v15, s[24:27], s3 offen offset:1024 lds
    buffer_load_dwordx4 v14, s[24:27], s3 offen offset:2048 lds
    buffer_load_dwordx4 v19, s[24:27], s3 offen offset:3072 lds
    s_add_u32 m0, s0, 135168
    s_add_u32 s3, s2, 32768
    buffer_load_dwordx4 v20, s[24:27], s3 offen lds
    buffer_load_dwordx4 v15, s[24:27], s3 offen offset:1024 lds
L_p2_short4:
    s_waitcnt vmcnt(0) lgkmcnt(0)
L_p2_done:
    s_lshl_b32 s54, s47, 6
    s_lshl_b32 s55, s48, 2
    s_add_u32 s54, s54, s55
    s_add_u32 s54, s54, s44
    s_lshl_b32 s54, s54, 10
    s_add_u32 s54, s54, 0x410000
    s_add_u32 s55, s54, 32768
    s_nop 3
    v_rcp_f32 v184, v160
    v_rcp_f32 v186, v176
    v_pk_mul_f32 v[152:153], v[152:153], v[184:185] op_sel_hi:[1,0]
    v_pk_mul_f32 v[154:155], v[154:155], v[184:185] op_sel_hi:[1,0]
    v_pk_mul_f32 v[156:157], v[156:157], v[184:185] op_sel_hi:[1,0]
    v_pk_mul_f32 v[158:159], v[158:159], v[184:185] op_sel_hi:[1,0]
    v_cvt_pk_bf16_f32 v160, v152, v153
    v_cvt_pk_bf16_f32 v161, v154, v155
    v_cvt_pk_bf16_f32 v162, v156, v157
    v_cvt_pk_bf16_f32 v163, v158, v159
    v_pk_mul_f32 v[168:169], v[168:169], v[186:187] op_sel_hi:[1,0]
    v_pk_mul_f32 v[170:171], v[170:171], v[186:187] op_sel_hi:[1,0]
    v_pk_mul_f32 v[172:173], v[172:173], v[186:187] op_sel_hi:[1,0]
    v_pk_mul_f32 v[174:175], v[174:175], v[186:187] op_sel_hi:[1,0]
    v_cvt_pk_bf16_f32 v176, v168, v169
    v_cvt_pk_bf16_f32 v177, v170, v171
    v_cvt_pk_bf16_f32 v178, v172, v173
    v_cvt_pk_bf16_f32 v179, v174, v175
    buffer_store_dwordx4 v[160:163], v1, s[28:31], s54 offen sc1
    buffer_store_dwordx4 v[176:179], v1, s[28:31], s55 offen sc1
    v_and_b32 v17, 31, v0
    v_lshlrev_b32 v17, 1, v17
    s_cmp_gt_u32 s46, 3
    s_subb_u32 s55, s46, 0
    s_cmp_gt_u32 s46, 11
    s_subb_u32 s55, s55, 0
    s_lshl_b32 s55, s55, 8
    s_lshl_b32 s56, s44, 6
    s_add_u32 s55, s55, s56
    buffer_load_ushort v14, v17, s[36:39], s55 offen
    v_bfe_u32 v17, v0, 2, 2
    v_lshlrev_b32 v22, 8, v17
    v_lshl_add_u32 v22, v17, 6, v22
    v_bfe_u32 v17, v0, 4, 1
    v_lshl_add_u32 v22, v17, 5, v22
    v_and_b32 v17, 3, v0
    v_lshl_add_u32 v22, v17, 3, v22
    v_lshrrev_b32 v17, 5, v0
    v_lshl_add_u32 v22, v17, 10, v22
    s_lshl_b32 s55, s44, 6
    v_xor_b32 v26, s55, v22
    v_add_u32 v27, 0x10000, v26
    v_lshrrev_b32 v17, 2, v0
    v_xor_b32 v17, v17, v0
    v_bfe_u32 v17, v17, 2, 1
    v_and_or_b32 v17, v0, 3, v17
    v_cmp_eq_u32 vcc, 0, v17
    v_mov_b32 v17, s63
    s_nop 0
    v_cndmask_b32 v92, 0, v17, vcc
    v_cndmask_b32 v93, 0, v17, vcc
    v_cndmask_b32 v94, 0, v17, vcc
    v_cndmask_b32 v95, 0, v17, vcc
    v_bfe_u32 v19, v0, 2, 2
    v_lshlrev_b32 v30, 7, v19
    v_lshrrev_b32 v19, 1, v19
    v_lshl_add_u32 v30, v19, 6, v30
    v_bfe_u32 v19, v0, 4, 1
    v_lshl_add_u32 v30, v19, 5, v30
    v_and_b32 v19, 3, v0
    v_lshl_add_u32 v30, v19, 3, v30
    v_lshrrev_b32 v19, 5, v0
    v_lshl_add_u32 v30, v19, 9, v30
    s_lshl_b32 s55, s61, 6
    s_lshl_b32 s56, s62, 5
    s_or_b32 s55, s55, s56
    v_xor_b32 v30, s55, v30
    s_add_u32 s55, s0, 131072
    v_add_u32 v30, s55, v30
    v_xor_b32 v31, 64, v30
    v_add_u32 v28, 14336, v20
    v_add_u32 v29, 21504, v20
    s_waitcnt vmcnt(3)
    s_barrier
    ds_read_b64_tr_b16 a[0:1], v30 offset:0
    ds_read_b64_tr_b16 a[2:3], v30 offset:1024
    ds_read_b64_tr_b16 a[4:5], v31 offset:0
    ds_read_b64_tr_b16 a[6:7], v31 offset:1024
    ds_read_b64_tr_b16 a[8:9], v30 offset:2048
    ds_read_b64_tr_b16 a[10:11], v30 offset:3072
    ds_read_b64_tr_b16 a[12:13], v31 offset:2048
    ds_read_b64_tr_b16 a[14:15], v31 offset:3072
    ds_read_b64_tr_b16 a[16:17], v30 offset:4096
    ds_read_b64_tr_b16 a[18:19], v30 offset:5120
    ds_read_b64_tr_b16 a[20:21], v31 offset:4096
    ds_read_b64_tr_b16 a[22:23], v31 offset:5120
    s_waitcnt lgkmcnt(0)
    s_add_u32 m0, s0, 131072
    s_add_u32 s3, s2, 49152
    buffer_load_dwordx4 v20, s[24:27], s3 offen lds
    buffer_load_dwordx4 v15, s[24:27], s3 offen offset:1024 lds
    buffer_load_dwordx4 v28, s[24:27], s3 offen offset:2048 lds
    buffer_load_dwordx4 v29, s[24:27], s3 offen offset:3072 lds
    s_add_u32 m0, s0, 135168
    s_add_u32 s3, s2, 81920
    buffer_load_dwordx4 v20, s[24:27], s3 offen lds
    buffer_load_dwordx4 v15, s[24:27], s3 offen offset:1024 lds
    ds_read_b64_tr_b16 v[32:33], v26 offset:0
    ds_read_b64_tr_b16 v[34:35], v26 offset:2048
    ds_read_b64_tr_b16 v[36:37], v26 offset:4096
    ds_read_b64_tr_b16 v[38:39], v26 offset:6144
    ds_read_b64_tr_b16 v[40:41], v26 offset:8192
    ds_read_b64_tr_b16 v[42:43], v26 offset:10240
    ds_read_b64_tr_b16 v[44:45], v26 offset:12288
    ds_read_b64_tr_b16 v[46:47], v26 offset:14336
    ds_read_b64_tr_b16 v[48:49], v26 offset:16384
    ds_read_b64_tr_b16 v[50:51], v26 offset:18432
    ds_read_b64_tr_b16 v[52:53], v26 offset:20480
    ds_read_b64_tr_b16 v[54:55], v26 offset:22528
    ds_read_b64_tr_b16 v[56:57], v26 offset:24576
    ds_read_b64_tr_b16 v[58:59], v26 offset:26624
    ds_read_b64_tr_b16 v[60:61], v26 offset:28672
    ds_read_b64_tr_b16 v[62:63], v26 offset:30720
    s_waitcnt lgkmcnt(14)
    v_mfma_f32_16x16x32_bf16 v[88:91], v[92:95], v[32:35], 0
    s_waitcnt lgkmcnt(12)
    v_mfma_f32_16x16x32_bf16 v[88:91], v[92:95], v[36:39], v[88:91]
    s_waitcnt lgkmcnt(10)
    v_mfma_f32_16x16x32_bf16 v[88:91], v[92:95], v[40:43], v[88:91]
    s_waitcnt lgkmcnt(8)
    v_mfma_f32_16x16x32_bf16 v[88:91], v[92:95], v[44:47], v[88:91]
    ds_read_b64_tr_b16 v[32:33], v26 offset:32768
    ds_read_b64_tr_b16 v[34:35], v26 offset:34816
    ds_read_b64_tr_b16 v[36:37], v26 offset:36864
    ds_read_b64_tr_b16 v[38:39], v26 offset:38912
    ds_read_b64_tr_b16 v[40:41], v26 offset:40960
    ds_read_b64_tr_b16 v[42:43], v26 offset:43008
    ds_read_b64_tr_b16 v[44:45], v26 offset:45056
    ds_read_b64_tr_b16 v[46:47], v26 offset:47104
    s_waitcnt lgkmcnt(14)
    v_mfma_f32_16x16x32_bf16 v[88:91], v[92:95], v[48:51], v[88:91]
    s_waitcnt lgkmcnt(12)
    v_mfma_f32_16x16x32_bf16 v[88:91], v[92:95], v[52:55], v[88:91]
    s_waitcnt lgkmcnt(10)
    v_mfma_f32_16x16x32_bf16 v[88:91], v[92:95], v[56:59], v[88:91]
    s_waitcnt lgkmcnt(8)
    v_mfma_f32_16x16x32_bf16 v[88:91], v[92:95], v[60:63], v[88:91]
    ds_read_b64_tr_b16 v[48:49], v26 offset:49152
    ds_read_b64_tr_b16 v[50:51], v26 offset:51200
    ds_read_b64_tr_b16 v[52:53], v26 offset:53248
    ds_read_b64_tr_b16 v[54:55], v26 offset:55296
    ds_read_b64_tr_b16 v[56:57], v26 offset:57344
    ds_read_b64_tr_b16 v[58:59], v26 offset:59392
    ds_read_b64_tr_b16 v[60:61], v26 offset:61440
    ds_read_b64_tr_b16 v[62:63], v26 offset:63488
    s_waitcnt lgkmcnt(14)
    v_mfma_f32_16x16x32_bf16 v[88:91], v[92:95], v[32:35], v[88:91]
    s_waitcnt lgkmcnt(12)
    v_mfma_f32_16x16x32_bf16 v[88:91], v[92:95], v[36:39], v[88:91]
    s_waitcnt lgkmcnt(10)
    v_mfma_f32_16x16x32_bf16 v[88:91], v[92:95], v[40:43], v[88:91]
    s_waitcnt lgkmcnt(8)
    v_mfma_f32_16x16x32_bf16 v[88:91], v[92:95], v[44:47], v[88:91]
    s_waitcnt lgkmcnt(6)
    v_mfma_f32_16x16x32_bf16 v[88:91], v[92:95], v[48:51], v[88:91]
    s_waitcnt lgkmcnt(4)
    v_mfma_f32_16x16x32_bf16 v[88:91], v[92:95], v[52:55], v[88:91]
    s_waitcnt lgkmcnt(2)
    v_mfma_f32_16x16x32_bf16 v[88:91], v[92:95], v[56:59], v[88:91]
    s_waitcnt lgkmcnt(0)
    v_mfma_f32_16x16x32_bf16 v[88:91], v[92:95], v[60:63], v[88:91]
    s_waitcnt vmcnt(7)
    s_barrier
    s_cmp_lg_u32 s44, 0
    s_cbranch_scc1 L_w0_10
    s_add_u32 s54, s50, 9
    v_mov_b32 v18, s54
    v_mov_b32 v19, s51
    s_lshl_b32 s55, s45, 7
    s_lshl_b32 s56, s46, 3
    s_add_u32 s55, s55, s56
    s_add_u32 s55, s55, 0x1000
    v_mov_b32 v17, 0
    s_mov_b64 exec, 1
    s_cmp_eq_u32 s52, 1
    s_cbranch_scc1 L_fast_11
    buffer_store_dwordx2 v[18:19], v17, s[28:31], s55 offen sc1
    s_branch L_stdone_12
L_fast_11:
    buffer_store_dwordx2 v[18:19], v17, s[28:31], s55 offen
L_stdone_12:
    s_mov_b64 exec, -1
L_w0_10:
    s_cmp_lg_u32 s44, 0
    s_cbranch_scc1 L_w0_13
    s_and_b32 s56, s46, 8
    s_lshl_b32 s56, 0xff, s56
    s_mov_b32 s57, 0
    v_and_b32 v17, 15, v0
    v_lshlrev_b32 v17, 3, v17
    s_lshl_b32 s55, s45, 7
    s_add_u32 s55, s55, 0x1000
    s_add_u32 s54, s50, 9
    s_mov_b32 s59, 0x40000
    s_waitcnt vmcnt(0) lgkmcnt(0)
    s_nop 7
L_poll_14:
    buffer_load_dwordx2 v[18:19], v17, s[28:31], s55 offen sc1
    s_waitcnt vmcnt(0)
    v_subrev_u32 v18, s54, v18
    v_cmp_eq_u32 vcc, s51, v19
    v_cmp_gt_u32 s[100:101], 3, v18
    s_and_b64 vcc, vcc, s[100:101]
    s_andn2_b64 s[100:101], s[56:57], vcc
    s_cbranch_scc0 L_polldone_15
    s_sub_u32 s59, s59, 1
    s_cbranch_scc1 L_pollto_16
    s_branch L_poll_14
L_pollto_16:
    v_mov_b32 v18, 257
    v_mov_b32 v19, 0
    global_store_dword v19, v18, s[6:7]
    s_waitcnt vmcnt(0)
L_polldone_15:
L_w0_13:
    s_barrier
    s_lshl_b32 s54, s47, 6
    s_lshl_b32 s55, s44, 3
    s_add_u32 s54, s54, s55
    s_lshl_b32 s54, s54, 10
    s_add_u32 s54, s54, 0x410000
    s_add_u32 s58, s54, 0
    buffer_load_dwordx4 v[32:35], v1, s[28:31], s58 offen offset:0 sc1
    buffer_load_dwordx4 v[36:39], v1, s[28:31], s58 offen offset:1024 sc1
    buffer_load_dwordx4 v[40:43], v1, s[28:31], s58 offen offset:2048 sc1
    buffer_load_dwordx4 v[44:47], v1, s[28:31], s58 offen offset:3072 sc1
    ds_read_b64_tr_b16 v[128:129], v27 offset:0
    ds_read_b64_tr_b16 v[130:131], v27 offset:2048
    ds_read_b64_tr_b16 v[132:133], v27 offset:4096
    ds_read_b64_tr_b16 v[134:135], v27 offset:6144
    ds_read_b64_tr_b16 v[136:137], v27 offset:8192
    ds_read_b64_tr_b16 v[138:139], v27 offset:10240
    ds_read_b64_tr_b16 v[140:141], v27 offset:12288
    ds_read_b64_tr_b16 v[142:143], v27 offset:14336
    ds_read_b64_tr_b16 v[144:145], v27 offset:16384
    s_add_u32 s58, s54, 4096
    buffer_load_dwordx4 v[48:51], v1, s[28:31], s58 offen offset:0 sc1
    ds_read_b64_tr_b16 v[146:147], v27 offset:18432
    ds_read_b64_tr_b16 v[148:149], v27 offset:20480
    ds_read_b64_tr_b16 v[150:151], v27 offset:22528
    ds_read_b64_tr_b16 v[152:153], v27 offset:24576
    ds_read_b64_tr_b16 v[154:155], v27 offset:26624
    ds_read_b64_tr_b16 v[156:157], v27 offset:28672
    ds_read_b64_tr_b16 v[158:159], v27 offset:30720
    s_waitcnt lgkmcnt(14)
    v_mfma_f32_16x16x32_bf16 v[88:91], v[92:95], v[128:131], v[88:91]
    s_waitcnt lgkmcnt(12)
    v_mfma_f32_16x16x32_bf16 v[88:91], v[92:95], v[132:135], v[88:91]
    s_waitcnt lgkmcnt(10)
    v_mfma_f32_16x16x32_bf16 v[88:91], v[92:95], v[136:139], v[88:91]
    buffer_load_dwordx4 v[52:55], v1, s[28:31], s58 offen offset:1024 sc1
    s_waitcnt lgkmcnt(8)
    v_mfma_f32_16x16x32_bf16 v[88:91], v[92:95], v[140:143], v[88:91]
    ds_read_b64_tr_b16 v[128:129], v27 offset:32768
    ds_read_b64_tr_b16 v[130:131], v27 offset:34816
    ds_read_b64_tr_b16 v[132:133], v27 offset:36864
    ds_read_b64_tr_b16 v[134:135], v27 offset:38912
    ds_read_b64_tr_b16 v[136:137], v27 offset:40960
    ds_read_b64_tr_b16 v[138:139], v27 offset:43008
    ds_read_b64_tr_b16 v[140:141], v27 offset:45056
    ds_read_b64_tr_b16 v[142:143], v27 offset:47104
    s_waitcnt lgkmcnt(14)
    v_mfma_f32_16x16x32_bf16 v[88:91], v[92:95], v[144:147], v[88:91]
    buffer_load_dwordx4 v[56:59], v1, s[28:31], s58 offen offset:2048 sc1
    s_waitcnt lgkmcnt(12)
    v_mfma_f32_16x16x32_bf16 v[88:91], v[92:95], v[148:151], v[88:91]
    s_waitcnt lgkmcnt(10)
    v_mfma_f32_16x16x32_bf16 v[88:91], v[92:95], v[152:155], v[88:91]
    s_waitcnt lgkmcnt(8)
    v_mfma_f32_16x16x32_bf16 v[88:91], v[92:95], v[156:159], v[88:91]
    ds_read_b64_tr_b16 v[144:145], v27 offset:49152
    ds_read_b64_tr_b16 v[146:147], v27 offset:51200
    ds_read_b64_tr_b16 v[148:149], v27 offset:53248
    ds_read_b64_tr_b16 v[150:151], v27 offset:55296
    ds_read_b64_tr_b16 v[152:153], v27 offset:57344
    ds_read_b64_tr_b16 v[154:155], v27 offset:59392
    ds_read_b64_tr_b16 v[156:157], v27 offset:61440
    buffer_load_dwordx4 v[60:63], v1, s[28:31], s58 offen offset:3072 sc1
    ds_read_b64_tr_b16 v[158:159], v27 offset:63488
    s_waitcnt lgkmcnt(14)
    v_mfma_f32_16x16x32_bf16 v[88:91], v[92:95], v[128:131], v[88:91]
    s_waitcnt lgkmcnt(12)
    v_mfma_f32_16x16x32_bf16 v[88:91], v[92:95], v[132:135], v[88:91]
    s_waitcnt lgkmcnt(10)
    v_mfma_f32_16x16x32_bf16 v[88:91], v[92:95], v[136:139], v[88:91]
    s_waitcnt lgkmcnt(8)
    v_mfma_f32_16x16x32_bf16 v[88:91], v[92:95], v[140:143], v[88:91]
    s_waitcnt lgkmcnt(6)
    v_mfma_f32_16x16x32_bf16 v[88:91], v[92:95], v[144:147], v[88:91]
    s_waitcnt lgkmcnt(4)
    v_mfma_f32_16x16x32_bf16 v[88:91], v[92:95], v[148:151], v[88:91]
    s_waitcnt lgkmcnt(2)
    v_mfma_f32_16x16x32_bf16 v[88:91], v[92:95], v[152:155], v[88:91]
    s_waitcnt lgkmcnt(0)
    v_mfma_f32_16x16x32_bf16 v[88:91], v[92:95], v[156:159], v[88:91]
    s_nop 7
    v_cvt_pk_bf16_f32 v128, v88, v88
    s_add_u32 s58, s54, 32768
    buffer_load_dwordx4 v[64:67], v1, s[28:31], s58 offen offset:0 sc1
    v_and_b32 v17, 0xffff0000, v128
    v_sub_f32 v129, v88, v17
    v_cvt_pk_bf16_f32 v129, v129, 0
    s_waitcnt vmcnt(15)
    v_lshl_or_b32 v129, v14, 16, v129
    v_mov_b32 v130, v14
    v_mov_b32 v131, 0
    v_accvgpr_write_b32 a224, v128
    v_accvgpr_write_b32 a225, v129
    v_accvgpr_write_b32 a226, v130
    v_accvgpr_write_b32 a227, v131
    buffer_load_dwordx4 v[68:71], v1, s[28:31], s58 offen offset:1024 sc1
    s_waitcnt vmcnt(10)
    ds_read_b64_tr_b16 a[24:25], v30 offset:0
    ds_read_b64_tr_b16 a[26:27], v30 offset:1024
    ds_read_b64_tr_b16 a[28:29], v31 offset:0
    ds_read_b64_tr_b16 a[30:31], v31 offset:1024
    ds_read_b64_tr_b16 a[32:33], v30 offset:2048
    ds_read_b64_tr_b16 a[34:35], v30 offset:3072
    ds_read_b64_tr_b16 a[36:37], v31 offset:2048
    ds_read_b64_tr_b16 a[38:39], v31 offset:3072
    ds_read_b64_tr_b16 a[40:41], v30 offset:4096
    ds_read_b64_tr_b16 a[42:43], v30 offset:5120
    ds_read_b64_tr_b16 a[44:45], v31 offset:4096
    ds_read_b64_tr_b16 a[46:47], v31 offset:5120
    s_waitcnt vmcnt(9)
    v_mfma_f32_32x32x16_bf16 v[96:111], v[192:195], v[32:35], 0
    buffer_load_dwordx4 v[72:75], v1, s[28:31], s58 offen offset:2048 sc1
    s_lshl_b32 s4, s47, 6
    s_lshl_b32 s5, s48, 2
    v_mfma_f32_32x32x16_bf16 v[112:127], v[196:199], v[32:35], 0
    s_add_u32 s4, s4, s5
    s_add_u32 s4, s4, s44
    s_lshl_b32 s4, s4, 10
    s_waitcnt vmcnt(9)
    v_mfma_f32_32x32x16_bf16 v[96:111], v[200:203], v[36:39], v[96:111]
    buffer_load_dwordx4 v[76:79], v1, s[28:31], s58 offen offset:3072 sc1
    s_add_u32 s4, s4, 0x610000
    s_add_u32 s5, s4, 32768
    v_mfma_f32_32x32x16_bf16 v[112:127], v[204:207], v[36:39], v[112:127]
    s_lshl_b32 s60, s47, 1
    s_add_u32 s60, s60, s62
    s_lshl_b32 s60, s60, 11
    s_waitcnt vmcnt(9)
    v_mfma_f32_32x32x16_bf16 v[96:111], v[208:211], v[40:43], v[96:111]
    s_add_u32 s58, s54, 36864
    buffer_load_dwordx4 v[80:83], v1, s[28:31], s58 offen offset:0 sc1
    s_lshr_b32 s49, s48, 1
    s_lshl_b32 s49, s49, 9
    v_mfma_f32_32x32x16_bf16 v[112:127], v[212:215], v[40:43], v[112:127]
    s_add_u32 s60, s60, s49
    s_and_b32 s49, s48, 1
    s_lshl_b32 s49, s49, 3
    s_waitcnt vmcnt(9)
    v_mfma_f32_32x32x16_bf16 v[96:111], v[216:219], v[44:47], v[96:111]
    buffer_load_dwordx4 v[84:87], v1, s[28:31], s58 offen offset:1024 sc1
    s_add_u32 s60, s60, s49
    s_add_u32 s60, s60, 0xf20000
    v_mfma_f32_32x32x16_bf16 v[112:127], v[220:223], v[44:47], v[112:127]
    s_xor_b32 s55, s44, 1
    s_mul_i32 s55, s55, 6144
    s_add_u32 s55, s55, 131072
    s_waitcnt vmcnt(9)
    v_mfma_f32_32x32x16_bf16 v[96:111], v[224:227], v[48:51], v[96:111]
    buffer_load_dwordx4 v[88:91], v1, s[28:31], s58 offen offset:2048 sc1
    v_add_u32 v22, s55, v1
    s_xor_b32 s55, s44, 2
    s_mul_i32 s55, s55, 6144
    v_mfma_f32_32x32x16_bf16 v[112:127], v[228:231], v[48:51], v[112:127]
    s_add_u32 s55, s55, 133120
    v_add_u32 v23, s55, v1
    s_waitcnt vmcnt(9)
    v_mfma_f32_32x32x16_bf16 v[96:111], v[232:235], v[52:55], v[96:111]
    buffer_load_dwordx4 v[92:95], v1, s[28:31], s58 offen offset:3072 sc1
    s_xor_b32 s55, s44, 3
    s_mul_i32 s55, s55, 6144
    s_add_u32 s55, s55, 135168
    v_mfma_f32_32x32x16_bf16 v[112:127], v[236:239], v[52:55], v[112:127]
    v_add_u32 v24, s55, v1
    s_mul_i32 s55, s44, 6144
    s_waitcnt vmcnt(9)
    v_mfma_f32_32x32x16_bf16 v[96:111], v[240:243], v[56:59], v[96:111]
    s_lshl_b32 s56, s45, 4
    s_add_u32 s56, s56, s46
    s_lshl_b32 s56, s56, 2
    s_add_u32 s56, s56, s44
    v_lshlrev_b32 v19, 7, v0
    s_mul_i32 s57, s56, 1792
    s_mov_b64 exec, 0x3fff
    buffer_load_dword v19, v19, s[24:27], s57 offen
    s_mov_b64 exec, -1
    s_add_u32 s55, s55, 131072
    v_add_u32 v25, s55, v1
    v_and_b32 v26, 31, v0
    v_mfma_f32_32x32x16_bf16 v[112:127], v[244:247], v[56:59], v[112:127]
    v_lshlrev_b32 v27, 3, v26
    v_lshlrev_b32 v26, 4, v26
    s_waitcnt vmcnt(9)
    v_mfma_f32_32x32x16_bf16 v[96:111], v[248:251], v[60:63], v[96:111]
    s_lshl_b32 s55, s44, 9
    s_add_u32 s55, s55, 161792
    v_add_u32 v28, s55, v27
    v_mfma_f32_32x32x16_bf16 v[112:127], v[252:255], v[60:63], v[112:127]
    s_lshl_b32 s55, s62, 8
    s_add_u32 s55, s55, 161792
    v_add_u32 v27, s55, v27
    s_waitcnt vmcnt(8)
    v_mfma_f32_32x32x16_bf16 v[128:143], v[192:195], v[64:67], 0
    v_lshlrev_b32 v160, 16, v2
    v_and_b32 v161, 0xffff0000, v2
    v_lshlrev_b32 v162, 16, v3
    v_and_b32 v163, 0xffff0000, v3
    v_mfma_f32_32x32x16_bf16 v[144:159], v[196:199], v[64:67], 0
    v_lshlrev_b32 v164, 16, v4
    v_and_b32 v165, 0xffff0000, v4
    v_lshlrev_b32 v166, 16, v5
    v_and_b32 v167, 0xffff0000, v5
    s_waitcnt vmcnt(7)
    v_mfma_f32_32x32x16_bf16 v[128:143], v[200:203], v[68:71], v[128:143]
    s_waitcnt lgkmcnt(0)
    s_barrier
    v_mfma_f32_32x32x16_bf16 v[144:159], v[204:207], v[68:71], v[144:159]
    s_waitcnt vmcnt(6)
    v_mfma_f32_32x32x16_bf16 v[128:143], v[208:211], v[72:75], v[128:143]
    ds_write_b128 v22, v[104:107] offset:0
    v_mfma_f32_32x32x16_bf16 v[144:159], v[212:215], v[72:75], v[144:159]
    ds_write_b128 v22, v[108:111] offset:1024
    s_waitcnt vmcnt(5)
    v_mfma_f32_32x32x16_bf16 v[128:143], v[216:219], v[76:79], v[128:143]
    ds_write_b128 v23, v[112:115] offset:0
    v_mfma_f32_32x32x16_bf16 v[144:159], v[220:223], v[76:79], v[144:159]
    ds_write_b128 v23, v[116:119] offset:1024
    s_waitcnt vmcnt(4)
    v_mfma_f32_32x32x16_bf16 v[128:143], v[224:227], v[80:83], v[128:143]
    ds_write_b128 v24, v[120:123] offset:0
    v_mfma_f32_32x32x16_bf16 v[144:159], v[228:231], v[80:83], v[144:159]
    ds_write_b128 v24, v[124:127] offset:1024
    s_waitcnt vmcnt(3)
    v_mfma_f32_32x32x16_bf16 v[128:143], v[232:235], v[84:87], v[128:143]
    v_mfma_f32_32x32x16_bf16 v[144:159], v[236:239], v[84:87], v[144:159]
    s_waitcnt lgkmcnt(0)
    s_barrier
    ds_read_b128 v[168:171], v25 offset:0
    ds_read_b128 v[172:175], v25 offset:1024
    ds_read_b128 v[176:179], v25 offset:2048
    ds_read_b128 v[180:183], v25 offset:3072
    ds_read_b128 v[184:187], v25 offset:4096
    ds_read_b128 v[188:191], v25 offset:5120
    s_waitcnt vmcnt(2)
    v_mfma_f32_32x32x16_bf16 v[128:143], v[240:243], v[88:91], v[128:143]
    v_add_f32 v96, v96, v160
    v_add_f32 v97, v97, v161
    v_add_f32 v98, v98, v162
    v_add_f32 v99, v99, v163
    v_mfma_f32_32x32x16_bf16 v[144:159], v[244:247], v[88:91], v[144:159]
    v_add_f32 v100, v100, v164
    v_add_f32 v101, v101, v165
    v_add_f32 v102, v102, v166
    v_add_f32 v103, v103, v167
    s_waitcnt vmcnt(1)
    v_mfma_f32_32x32x16_bf16 v[128:143], v[248:251], v[92:95], v[128:143]
    v_lshlrev_b32 v160, 16, v6
    v_and_b32 v161, 0xffff0000, v6
    v_lshlrev_b32 v162, 16, v7
    v_and_b32 v163, 0xffff0000, v7
    v_mfma_f32_32x32x16_bf16 v[144:159], v[252:255], v[92:95], v[144:159]
    v_lshlrev_b32 v164, 16, v8
    v_and_b32 v165, 0xffff0000, v8
    v_lshlrev_b32 v166, 16, v9
    v_and_b32 v167, 0xffff0000, v9
    s_waitcnt lgkmcnt(5)
    v_add_f32 v96, v96, v168
    v_add_f32 v97, v97, v169
    v_add_f32 v98, v98, v170
    v_add_f32 v99, v99, v171
    s_waitcnt lgkmcnt(4)
    v_add_f32 v100, v100, v172
    v_add_f32 v101, v101, v173
    v_add_f32 v102, v102, v174
    v_add_f32 v103, v103, v175
    s_waitcnt lgkmcnt(0)
    s_barrier
    ds_write_b128 v22, v[136:139] offset:0
    ds_write_b128 v22, v[140:143] offset:1024
    ds_write_b128 v23, v[144:147] offset:0
    ds_write_b128 v23, v[148:151] offset:1024
    ds_write_b128 v24, v[152:155] offset:0
    ds_write_b128 v24, v[156:159] offset:1024
    v_add_f32 v96, v96, v176
    v_add_f32 v97, v97, v177
    v_add_f32 v98, v98, v178
    v_add_f32 v99, v99, v179
    v_add_f32 v100, v100, v180
    v_add_f32 v101, v101, v181
    v_add_f32 v102, v102, v182
    v_add_f32 v103, v103, v183
    v_add_f32 v96, v96, v184
    v_add_f32 v97, v97, v185
    v_add_f32 v98, v98, v186
    v_add_f32 v99, v99, v187
    v_add_f32 v100, v100, v188
    v_add_f32 v101, v101, v189
    v_add_f32 v102, v102, v190
    v_add_f32 v103, v103, v191
    v_cvt_pk_bf16_f32 v2, v96, v97
    v_cvt_pk_bf16_f32 v3, v98, v99
    v_cvt_pk_bf16_f32 v4, v100, v101
    v_cvt_pk_bf16_f32 v5, v102, v103
    v_pk_add_f32 v[128:129], v[128:129], v[160:161]
    v_pk_add_f32 v[130:131], v[130:131], v[162:163]
    v_pk_add_f32 v[132:133], v[132:133], v[164:165]
    v_pk_add_f32 v[134:135], v[134:135], v[166:167]
    s_waitcnt lgkmcnt(0)
    s_barrier
    ds_read_b128 v[168:171], v25 offset:0
    ds_read_b128 v[172:175], v25 offset:1024
    ds_read_b128 v[176:179], v25 offset:2048
    ds_read_b128 v[180:183], v25 offset:3072
    ds_read_b128 v[184:187], v25 offset:4096
    ds_read_b128 v[188:191], v25 offset:5120
    buffer_store_dwordx4 v[2:5], v1, s[28:31], s4 offen sc1
    v_mov_b32 v32, 0
    v_mov_b32 v33, 0
    v_mov_b32 v34, 0
    v_mov_b32 v35, 0
    v_dot2c_f32_bf16 v32, s63, v2
    v_dot2c_f32_bf16 v33, v2, v2
    v_dot2c_f32_bf16 v32, s63, v3
    v_dot2c_f32_bf16 v33, v3, v3
    v_dot2c_f32_bf16 v32, s63, v4
    v_dot2c_f32_bf16 v33, v4, v4
    v_dot2c_f32_bf16 v32, s63, v5
    v_dot2c_f32_bf16 v33, v5, v5
    s_waitcnt lgkmcnt(3)
    v_pk_add_f32 v[168:169], v[168:169], v[176:177]
    s_waitcnt lgkmcnt(1)
    v_pk_add_f32 v[128:129], v[128:129], v[184:185]
    v_pk_add_f32 v[170:171], v[170:171], v[178:179]
    v_pk_add_f32 v[130:131], v[130:131], v[186:187]
    v_pk_add_f32 v[172:173], v[172:173], v[180:181]
    s_waitcnt lgkmcnt(0)
    v_pk_add_f32 v[132:133], v[132:133], v[188:189]
    v_pk_add_f32 v[174:175], v[174:175], v[182:183]
    v_pk_add_f32 v[134:135], v[134:135], v[190:191]
    v_pk_add_f32 v[128:129], v[128:129], v[168:169]
    v_pk_add_f32 v[130:131], v[130:131], v[170:171]
    v_pk_add_f32 v[132:133], v[132:133], v[172:173]
    v_pk_add_f32 v[134:135], v[134:135], v[174:175]
    v_cvt_pk_bf16_f32 v6, v128, v129
    v_cvt_pk_bf16_f32 v7, v130, v131
    v_cvt_pk_bf16_f32 v8, v132, v133
    v_cvt_pk_bf16_f32 v9, v134, v135
    buffer_store_dwordx4 v[6:9], v1, s[28:31], s5 offen sc1
    v_dot2c_f32_bf16 v34, s63, v6
    v_dot2c_f32_bf16 v35, v6, v6
    v_dot2c_f32_bf16 v34, s63, v7
    v_dot2c_f32_bf16 v35, v7, v7
    v_dot2c_f32_bf16 v34, s63, v8
    v_dot2c_f32_bf16 v35, v8, v8
    v_dot2c_f32_bf16 v34, s63, v9
    v_dot2c_f32_bf16 v35, v9, v9
    v_mov_b32 v36, v32
    v_mov_b32 v37, v33
    v_mov_b32 v38, v34
    v_mov_b32 v39, v35
    s_nop 0
    v_permlane32_swap_b32 v32, v36
    v_permlane32_swap_b32 v33, v37
    v_permlane32_swap_b32 v34, v38
    v_permlane32_swap_b32 v35, v39
    v_add_f32 v32, v32, v36
    v_add_f32 v33, v33, v37
    v_add_f32 v34, v34, v38
    v_add_f32 v35, v35, v39
    ds_write_b64 v28, v[32:33]
    ds_write_b64 v28, v[34:35] offset:256
    s_waitcnt lgkmcnt(0)
    s_barrier
    ds_read_b64 v[40:41], v27 offset:0
    ds_read_b64 v[42:43], v27 offset:512
    ds_read_b64 v[44:45], v27 offset:1024
    ds_read_b64 v[46:47], v27 offset:1536
    s_lshl_b32 s55, s61, 13
    s_lshl_b32 s56, s62, 10
    s_add_u32 s55, s55, s56
    s_add_u32 s55, s55, 137216
    v_add_u32 v17, s55, v1
    ds_write_b128 v17, a[224:227]
    s_waitcnt lgkmcnt(3)
    v_pk_add_f32 v[40:41], v[40:41], v[42:43]
    s_waitcnt lgkmcnt(1)
    v_pk_add_f32 v[44:45], v[44:45], v[46:47]
    v_pk_add_f32 v[40:41], v[40:41], v[44:45]
    s_mov_b64 exec, s[96:97]
    buffer_store_dwordx2 v[40:41], v26, s[28:31], s60 offen sc1
    s_mov_b64 exec, -1
    v_add_u32 v21, 14336, v20
    v_add_u32 v248, 21504, v20
    s_add_u32 m0, s0, 131072
    s_add_u32 s3, s2, 98304
    buffer_load_dwordx4 v20, s[24:27], s3 offen lds
    buffer_load_dwordx4 v15, s[24:27], s3 offen offset:1024 lds
    buffer_load_dwordx4 v21, s[24:27], s3 offen offset:2048 lds
    buffer_load_dwordx4 v248, s[24:27], s3 offen offset:3072 lds
    s_add_u32 m0, s0, 135168
    s_add_u32 s3, s2, 131072
    buffer_load_dwordx4 v20, s[24:27], s3 offen lds
    buffer_load_dwordx4 v15, s[24:27], s3 offen offset:1024 lds
    s_waitcnt lgkmcnt(0)
    s_waitcnt vmcnt(6)
    s_barrier
    s_cmp_lg_u32 s44, 0
    s_cbranch_scc1 L_w0_17
    s_add_u32 s54, s50, 10
    v_mov_b32 v18, s54
    v_mov_b32 v19, s51
    s_lshl_b32 s55, s45, 7
    s_lshl_b32 s56, s46, 3
    s_add_u32 s55, s55, s56
    s_add_u32 s55, s55, 0x1000
    v_mov_b32 v17, 0
    s_mov_b64 exec, 1
    s_cmp_eq_u32 s52, 1
    s_cbranch_scc1 L_fast_18
    buffer_store_dwordx2 v[18:19], v17, s[28:31], s55 offen sc1
    s_branch L_stdone_19
L_fast_18:
    buffer_store_dwordx2 v[18:19], v17, s[28:31], s55 offen
L_stdone_19:
    s_mov_b64 exec, -1
L_w0_17:
    s_cmp_eq_u32 s48, 3
    s_cbranch_scc1 L_p4_skip
    v_bfe_u32 v17, v0, 2, 2
    v_lshlrev_b32 v22, 8, v17
    v_lshl_add_u32 v22, v17, 6, v22
    v_bfe_u32 v17, v0, 4, 1
    v_lshl_add_u32 v22, v17, 5, v22
    v_and_b32 v17, 3, v0
    v_lshl_add_u32 v22, v17, 3, v22
    v_lshrrev_b32 v17, 5, v0
    v_lshl_add_u32 v22, v17, 10, v22
    v_xor_b32 v23, 64, v22
    v_xor_b32 v24, 128, v22
    v_xor_b32 v25, 192, v22
    s_lshl_b32 s4, s45, 2
    s_add_u32 s4, s4, s44
    s_lshl_b32 s5, s4, 11
    s_add_u32 s5, s5, 0xf20000
    s_mul_i32 s49, s4, 112
    s_lshl_b32 s4, s4, 15
    s_add_u32 s60, s4, 0x610000
    s_cmp_gt_u32 s46, 3
    s_subb_u32 s55, s46, 0
    s_cmp_gt_u32 s46, 11
    s_subb_u32 s55, s55, 0
    s_lshl_b32 s55, s55, 3
    s_add_u32 s49, s49, s55
    s_lshl_b32 s49, s49, 10
    s_add_u32 s49, s49, 0x810000
    s_add_u32 s58, s49, 4096
    v_add_u32 v14, 137216, v1
    ds_read_b64_tr_b16 a[168:169], v22 offset:0
    ds_read_b64_tr_b16 a[170:171], v22 offset:2048
    ds_read_b64_tr_b16 a[172:173], v23 offset:0
    ds_read_b64_tr_b16 a[174:175], v23 offset:2048
    ds_read_b64_tr_b16 a[176:177], v24 offset:0
    ds_read_b64_tr_b16 a[178:179], v24 offset:2048
    ds_read_b64_tr_b16 a[180:181], v25 offset:0
    ds_read_b64_tr_b16 a[182:183], v25 offset:2048
    ds_read_b64_tr_b16 a[184:185], v22 offset:4096
    ds_read_b64_tr_b16 a[186:187], v22 offset:6144
    ds_read_b64_tr_b16 a[188:189], v23 offset:4096
    ds_read_b64_tr_b16 a[190:191], v23 offset:6144
    ds_read_b64_tr_b16 a[192:193], v24 offset:4096
    ds_read_b64_tr_b16 a[194:195], v24 offset:6144
    s_cmp_lg_u32 s44, 0
    s_cbranch_scc1 L_w0_20
    s_mov_b32 s56, 65535
    s_mov_b32 s57, 0
    v_and_b32 v17, 15, v0
    v_lshlrev_b32 v17, 3, v17
    s_lshl_b32 s55, s45, 7
    s_add_u32 s55, s55, 0x1000
    s_add_u32 s54, s50, 10
    s_mov_b32 s59, 0x40000
    s_waitcnt vmcnt(0) lgkmcnt(0)
    s_nop 7
L_poll_21:
    buffer_load_dwordx2 v[18:19], v17, s[28:31], s55 offen sc1
    s_waitcnt vmcnt(0)
    v_subrev_u32 v18, s54, v18
    v_cmp_eq_u32 vcc, s51, v19
    v_cmp_gt_u32 s[100:101], 2, v18
    s_and_b64 vcc, vcc, s[100:101]
    s_andn2_b64 s[100:101], s[56:57], vcc
    s_cbranch_scc0 L_polldone_22
    s_sub_u32 s59, s59, 1
    s_cbranch_scc1 L_pollto_23
    s_branch L_poll_21
L_pollto_23:
    v_mov_b32 v18, 258
    v_mov_b32 v19, 0
    global_store_dword v19, v18, s[6:7]
    s_waitcnt vmcnt(0)
L_polldone_22:
L_w0_20:
    s_barrier
    s_add_u32 s4, s60, 0
    buffer_load_dwordx4 v[32:35], v1, s[28:31], s4 offen offset:0 sc1
    buffer_load_dwordx4 v[36:39], v1, s[28:31], s4 offen offset:1024 sc1
    buffer_load_dwordx4 v[40:43], v1, s[28:31], s4 offen offset:2048 sc1
    buffer_load_dwordx4 v[44:47], v1, s[28:31], s4 offen offset:3072 sc1
    s_cmp_lg_u32 s44, 0
    s_cbranch_scc1 L_w0_24
    s_cmp_lg_u32 s46, 0
    s_cbranch_scc1 L_nobump_25
    s_add_u32 s55, s53, 1
    v_mov_b32 v18, s55
    s_lshl_b32 s55, s45, 3
    v_mov_b32 v17, 0
    s_mov_b64 exec, 1
    buffer_store_dword v18, v17, s[28:31], s55 offen offset:0 sc1
    s_mov_b64 exec, -1
L_nobump_25:
L_w0_24:
    s_add_u32 s4, s60, 4096
    buffer_load_dwordx4 v[48:51], v1, s[28:31], s4 offen offset:0 sc1
    buffer_load_dwordx4 v[52:55], v1, s[28:31], s4 offen offset:1024 sc1
    buffer_load_dwordx4 v[56:59], v1, s[28:31], s4 offen offset:2048 sc1
    buffer_load_dwordx4 v[60:63], v1, s[28:31], s4 offen offset:3072 sc1
    s_add_u32 s4, s60, 8192
    buffer_load_dwordx4 v[64:67], v1, s[28:31], s4 offen offset:0 sc1
    s_waitcnt vmcnt(8) lgkmcnt(10)
    v_mfma_f32_32x32x16_bf16 v[160:175], a[168:171], v[32:35], 0
    ds_read_b64_tr_b16 a[196:197], v25 offset:4096
    ds_read_b64_tr_b16 a[198:199], v25 offset:6144
    buffer_load_dwordx4 v[224:227], v1, s[28:31], s5 offen offset:0 sc1
    ds_read_b64_tr_b16 a[48:49], v30 offset:0
    ds_read_b64_tr_b16 a[50:51], v30 offset:1024
    v_mfma_f32_32x32x16_bf16 v[176:191], a[172:175], v[32:35], 0
    ds_read_b64_tr_b16 a[168:169], v22 offset:8192
    ds_read_b64_tr_b16 a[170:171], v22 offset:10240
    ds_read_b64_tr_b16 a[52:53], v31 offset:0
    ds_read_b64_tr_b16 a[54:55], v31 offset:1024
    s_waitcnt lgkmcnt(14)
    v_mfma_f32_32x32x16_bf16 v[192:207], a[176:179], v[32:35], 0
    ds_read_b64_tr_b16 a[172:173], v23 offset:8192
    ds_read_b64_tr_b16 a[174:175], v23 offset:10240
    ds_read_b64_tr_b16 a[56:57], v30 offset:2048
    ds_read_b64_tr_b16 a[58:59], v30 offset:3072
    v_mfma_f32_32x32x16_bf16 v[208:223], a[180:183], v[32:35], 0
    ds_read_b64_tr_b16 a[176:177], v24 offset:8192
    ds_read_b64_tr_b16 a[178:179], v24 offset:10240
    buffer_load_dwordx4 v[228:231], v1, s[28:31], s5 offen offset:1024 sc1
    ds_read_b64_tr_b16 a[60:61], v31 offset:2048
    ds_read_b64_tr_b16 a[62:63], v31 offset:3072
    s_waitcnt vmcnt(9) lgkmcnt(15)
    v_mfma_f32_32x32x16_bf16 v[160:175], a[184:187], v[36:39], v[160:175]
    ds_read_b64_tr_b16 a[180:181], v25 offset:8192
    ds_read_b64_tr_b16 a[182:183], v25 offset:10240
    ds_read_b64_tr_b16 a[64:65], v30 offset:4096
    ds_read_b64_tr_b16 a[66:67], v30 offset:5120
    v_mfma_f32_32x32x16_bf16 v[176:191], a[188:191], v[36:39], v[176:191]
    ds_read_b64_tr_b16 a[184:185], v22 offset:12288
    ds_read_b64_tr_b16 a[186:187], v22 offset:14336
    ds_read_b64_tr_b16 a[68:69], v31 offset:4096
    ds_read_b64_tr_b16 a[70:71], v31 offset:5120
    s_waitcnt lgkmcnt(15)
    v_mfma_f32_32x32x16_bf16 v[192:207], a[192:195], v[36:39], v[192:207]
    ds_read_b64_tr_b16 a[188:189], v23 offset:12288
    ds_read_b64_tr_b16 a[190:191], v23 offset:14336
    buffer_load_dwordx4 v[68:71], v1, s[28:31], s4 offen offset:1024 sc1
    v_mfma_f32_32x32x16_bf16 v[208:223], a[196:199], v[36:39], v[208:223]
    ds_read_b64_tr_b16 a[192:193], v24 offset:12288
    ds_read_b64_tr_b16 a[194:195], v24 offset:14336
    s_waitcnt vmcnt(9) lgkmcnt(15)
    v_mfma_f32_32x32x16_bf16 v[160:175], a[168:171], v[40:43], v[160:175]
    ds_read_b64_tr_b16 a[196:197], v25 offset:12288
    ds_read_b64_tr_b16 a[198:199], v25 offset:14336
    s_waitcnt lgkmcnt(6)
    s_add_u32 m0, s0, 131072
    s_add_u32 s3, s2, 147456
    buffer_load_dwordx4 v20, s[24:27], s3 offen lds
    v_mfma_f32_32x32x16_bf16 v[176:191], a[172:175], v[40:43], v[176:191]
    ds_read_b64_tr_b16 a[168:169], v22 offset:16384
    ds_read_b64_tr_b16 a[170:171], v22 offset:18432
    buffer_load_dwordx4 v[72:75], v1, s[28:31], s4 offen offset:2048 sc1
    buffer_load_dwordx4 v15, s[24:27], s3 offen offset:1024 lds
    buffer_load_dwordx4 v21, s[24:27], s3 offen offset:2048 lds
    v_mfma_f32_32x32x16_bf16 v[192:207], a[176:179], v[40:43], v[192:207]
    ds_read_b64_tr_b16 a[172:173], v23 offset:16384
    ds_read_b64_tr_b16 a[174:175], v23 offset:18432
    buffer_load_dwordx4 v248, s[24:27], s3 offen offset:3072 lds
    s_add_u32 m0, s0, 135168
    s_add_u32 s3, s2, 180224
    buffer_load_dwordx4 v20, s[24:27], s3 offen lds
    v_mfma_f32_32x32x16_bf16 v[208:223], a[180:183], v[40:43], v[208:223]
    ds_read_b64_tr_b16 a[176:177], v24 offset:16384
    ds_read_b64_tr_b16 a[178:179], v24 offset:18432
    buffer_load_dwordx4 v15, s[24:27], s3 offen offset:1024 lds
    s_waitcnt vmcnt(15) lgkmcnt(10)
    v_mfma_f32_32x32x16_bf16 v[160:175], a[184:187], v[44:47], v[160:175]
    ds_read_b64_tr_b16 a[180:181], v25 offset:16384
    ds_read_b64_tr_b16 a[182:183], v25 offset:18432
    buffer_load_dwordx4 v[76:79], v1, s[28:31], s4 offen offset:3072 sc1
    v_mfma_f32_32x32x16_bf16 v[176:191], a[188:191], v[44:47], v[176:191]
    ds_read_b64_tr_b16 a[184:185], v22 offset:20480
    ds_read_b64_tr_b16 a[186:187], v22 offset:22528
    s_waitcnt lgkmcnt(10)
    v_mfma_f32_32x32x16_bf16 v[192:207], a[192:195], v[44:47], v[192:207]
    ds_read_b64_tr_b16 a[188:189], v23 offset:20480
    ds_read_b64_tr_b16 a[190:191], v23 offset:22528
    v_mfma_f32_32x32x16_bf16 v[208:223], a[196:199], v[44:47], v[208:223]
    ds_read_b64_tr_b16 a[192:193], v24 offset:20480
    ds_read_b64_tr_b16 a[194:195], v24 offset:22528
    s_add_u32 s4, s60, 12288
    buffer_load_dwordx4 v[80:83], v1, s[28:31], s4 offen offset:0 sc1
    s_waitcnt vmcnt(16) lgkmcnt(10)
    v_mfma_f32_32x32x16_bf16 v[160:175], a[168:171], v[48:51], v[160:175]
    ds_read_b64_tr_b16 a[196:197], v25 offset:20480
    ds_read_b64_tr_b16 a[198:199], v25 offset:22528
    v_mfma_f32_32x32x16_bf16 v[176:191], a[172:175], v[48:51], v[176:191]
    ds_read_b64_tr_b16 a[168:169], v22 offset:24576
    ds_read_b64_tr_b16 a[170:171], v22 offset:26624
    s_waitcnt lgkmcnt(10)
    v_mfma_f32_32x32x16_bf16 v[192:207], a[176:179], v[48:51], v[192:207]
    ds_read_b64_tr_b16 a[172:173], v23 offset:24576
    ds_read_b64_tr_b16 a[174:175], v23 offset:26624
    buffer_load_dwordx4 v[84:87], v1, s[28:31], s4 offen offset:1024 sc1
    v_mfma_f32_32x32x16_bf16 v[208:223], a[180:183], v[48:51], v[208:223]
    ds_read_b64_tr_b16 a[176:177], v24 offset:24576
    ds_read_b64_tr_b16 a[178:179], v24 offset:26624
    s_waitcnt vmcnt(16) lgkmcnt(10)
    v_mfma_f32_32x32x16_bf16 v[160:175], a[184:187], v[52:55], v[160:175]
    ds_read_b64_tr_b16 a[180:181], v25 offset:24576
    ds_read_b64_tr_b16 a[182:183], v25 offset:26624
    v_mfma_f32_32x32x16_bf16 v[176:191], a[188:191], v[52:55], v[176:191]
    ds_read_b64_tr_b16 a[184:185], v22 offset:28672
    ds_read_b64_tr_b16 a[186:187], v22 offset:30720
    buffer_load_dwordx4 v[88:91], v1, s[28:31], s4 offen offset:2048 sc1
    s_waitcnt lgkmcnt(10)
    v_mfma_f32_32x32x16_bf16 v[192:207], a[192:195], v[52:55], v[192:207]
    ds_read_b64_tr_b16 a[188:189], v23 offset:28672
    ds_read_b64_tr_b16 a[190:191], v23 offset:30720
    v_mfma_f32_32x32x16_bf16 v[208:223], a[196:199], v[52:55], v[208:223]
    ds_read_b64_tr_b16 a[192:193], v24 offset:28672
    ds_read_b64_tr_b16 a[194:195], v24 offset:30720
    s_waitcnt vmcnt(16) lgkmcnt(10)
    v_mfma_f32_32x32x16_bf16 v[160:175], a[168:171], v[56:59], v[160:175]
    ds_read_b64_tr_b16 a[196:197], v25 offset:28672
    ds_read_b64_tr_b16 a[198:199], v25 offset:30720
    buffer_load_dwordx4 v[92:95], v1, s[28:31], s4 offen offset:3072 sc1
    v_mfma_f32_32x32x16_bf16 v[176:191], a[172:175], v[56:59], v[176:191]
    ds_read_b64_tr_b16 a[168:169], v22 offset:32768
    ds_read_b64_tr_b16 a[170:171], v22 offset:34816
    s_waitcnt lgkmcnt(10)
    v_mfma_f32_32x32x16_bf16 v[192:207], a[176:179], v[56:59], v[192:207]
    ds_read_b64_tr_b16 a[172:173], v23 offset:32768
    ds_read_b64_tr_b16 a[174:175], v23 offset:34816
    v_mfma_f32_32x32x16_bf16 v[208:223], a[180:183], v[56:59], v[208:223]
    ds_read_b64_tr_b16 a[176:177], v24 offset:32768
    ds_read_b64_tr_b16 a[178:179], v24 offset:34816
    s_add_u32 s4, s60, 16384
    buffer_load_dwordx4 v[96:99], v1, s[28:31], s4 offen offset:0 sc1
    s_waitcnt vmcnt(17) lgkmcnt(10)
    v_mfma_f32_32x32x16_bf16 v[160:175], a[184:187], v[60:63], v[160:175]
    ds_read_b64_tr_b16 a[180:181], v25 offset:32768
    ds_read_b64_tr_b16 a[182:183], v25 offset:34816
    v_mfma_f32_32x32x16_bf16 v[176:191], a[188:191], v[60:63], v[176:191]
    ds_read_b64_tr_b16 a[184:185], v22 offset:36864
    ds_read_b64_tr_b16 a[186:187], v22 offset:38912
    s_waitcnt lgkmcnt(10)
    v_mfma_f32_32x32x16_bf16 v[192:207], a[192:195], v[60:63], v[192:207]
    ds_read_b64_tr_b16 a[188:189], v23 offset:36864
    ds_read_b64_tr_b16 a[190:191], v23 offset:38912
    buffer_load_dwordx4 v[100:103], v1, s[28:31], s4 offen offset:1024 sc1
    v_mfma_f32_32x32x16_bf16 v[208:223], a[196:199], v[60:63], v[208:223]
    ds_read_b64_tr_b16 a[192:193], v24 offset:36864
    ds_read_b64_tr_b16 a[194:195], v24 offset:38912
    s_waitcnt vmcnt(17) lgkmcnt(10)
    v_mfma_f32_32x32x16_bf16 v[160:175], a[168:171], v[64:67], v[160:175]
    ds_read_b64_tr_b16 a[196:197], v25 offset:36864
    ds_read_b64_tr_b16 a[198:199], v25 offset:38912
    v_mfma_f32_32x32x16_bf16 v[176:191], a[172:175], v[64:67], v[176:191]
    ds_read_b64_tr_b16 a[168:169], v22 offset:40960
    ds_read_b64_tr_b16 a[170:171], v22 offset:43008
    buffer_load_dwordx4 v[104:107], v1, s[28:31], s4 offen offset:2048 sc1
    s_waitcnt lgkmcnt(10)
    v_mfma_f32_32x32x16_bf16 v[192:207], a[176:179], v[64:67], v[192:207]
    ds_read_b64_tr_b16 a[172:173], v23 offset:40960
    ds_read_b64_tr_b16 a[174:175], v23 offset:43008
    v_mfma_f32_32x32x16_bf16 v[208:223], a[180:183], v[64:67], v[208:223]
    ds_read_b64_tr_b16 a[176:177], v24 offset:40960
    ds_read_b64_tr_b16 a[178:179], v24 offset:43008
    s_waitcnt vmcnt(15) lgkmcnt(10)
    v_mfma_f32_32x32x16_bf16 v[160:175], a[184:187], v[68:71], v[160:175]
    ds_read_b64_tr_b16 a[180:181], v25 offset:40960
    ds_read_b64_tr_b16 a[182:183], v25 offset:43008
    buffer_load_dwordx4 v[108:111], v1, s[28:31], s4 offen offset:3072 sc1
    v_mfma_f32_32x32x16_bf16 v[176:191], a[188:191], v[68:71], v[176:191]
    ds_read_b64_tr_b16 a[184:185], v22 offset:45056
    ds_read_b64_tr_b16 a[186:187], v22 offset:47104
    s_waitcnt lgkmcnt(10)
    v_mfma_f32_32x32x16_bf16 v[192:207], a[192:195], v[68:71], v[192:207]
    ds_read_b64_tr_b16 a[188:189], v23 offset:45056
    ds_read_b64_tr_b16 a[190:191], v23 offset:47104
    v_mfma_f32_32x32x16_bf16 v[208:223], a[196:199], v[68:71], v[208:223]
    ds_read_b64_tr_b16 a[192:193], v24 offset:45056
    ds_read_b64_tr_b16 a[194:195], v24 offset:47104
    s_add_u32 s4, s60, 20480
    buffer_load_dwordx4 v[112:115], v1, s[28:31], s4 offen offset:0 sc1
    s_waitcnt vmcnt(15) lgkmcnt(10)
    v_mfma_f32_32x32x16_bf16 v[160:175], a[168:171], v[72:75], v[160:175]
    ds_read_b64_tr_b16 a[196:197], v25 offset:45056
    ds_read_b64_tr_b16 a[198:199], v25 offset:47104
    v_mfma_f32_32x32x16_bf16 v[176:191], a[172:175], v[72:75], v[176:191]
    ds_read_b64_tr_b16 a[168:169], v22 offset:49152
    ds_read_b64_tr_b16 a[170:171], v22 offset:51200
    s_waitcnt lgkmcnt(10)
    v_mfma_f32_32x32x16_bf16 v[192:207], a[176:179], v[72:75], v[192:207]
    ds_read_b64_tr_b16 a[172:173], v23 offset:49152
    ds_read_b64_tr_b16 a[174:175], v23 offset:51200
    buffer_load_dwordx4 v[116:119], v1, s[28:31], s4 offen offset:1024 sc1
    s_waitcnt vmcnt(11)
    ds_read_b64_tr_b16 a[72:73], v30 offset:0
    ds_read_b64_tr_b16 a[74:75], v30 offset:1024
    v_mfma_f32_32x32x16_bf16 v[208:223], a[180:183], v[72:75], v[208:223]
    ds_read_b64_tr_b16 a[176:177], v24 offset:49152
    ds_read_b64_tr_b16 a[178:179], v24 offset:51200
    ds_read_b64_tr_b16 a[76:77], v31 offset:0
    ds_read_b64_tr_b16 a[78:79], v31 offset:1024
    s_waitcnt vmcnt(10) lgkmcnt(14)
    v_mfma_f32_32x32x16_bf16 v[160:175], a[184:187], v[76:79], v[160:175]
    ds_read_b64_tr_b16 a[180:181], v25 offset:49152
    ds_read_b64_tr_b16 a[182:183], v25 offset:51200
    ds_read_b64_tr_b16 a[80:81], v30 offset:2048
    ds_read_b64_tr_b16 a[82:83], v30 offset:3072
    v_add_f32 v252, v224, v226
    v_add_f32 v253, v225, v227
    v_mfma_f32_32x32x16_bf16 v[176:191], a[188:191], v[76:79], v[176:191]
    ds_read_b64_tr_b16 a[184:185], v22 offset:53248
    ds_read_b64_tr_b16 a[186:187], v22 offset:55296
    buffer_load_dwordx4 v[120:123], v1, s[28:31], s4 offen offset:2048 sc1
    ds_read_b64_tr_b16 a[84:85], v31 offset:2048
    ds_read_b64_tr_b16 a[86:87], v31 offset:3072
    s_waitcnt lgkmcnt(15)
    v_mfma_f32_32x32x16_bf16 v[192:207], a[192:195], v[76:79], v[192:207]
    ds_read_b64_tr_b16 a[188:189], v23 offset:53248
    ds_read_b64_tr_b16 a[190:191], v23 offset:55296
    ds_read_b64_tr_b16 a[88:89], v30 offset:4096
    ds_read_b64_tr_b16 a[90:91], v30 offset:5120
    v_add_f32 v254, v228, v230
    v_add_f32 v255, v229, v231
    v_mfma_f32_32x32x16_bf16 v[208:223], a[196:199], v[76:79], v[208:223]
    ds_read_b64_tr_b16 a[192:193], v24 offset:53248
    ds_read_b64_tr_b16 a[194:195], v24 offset:55296
    ds_read_b64_tr_b16 a[92:93], v31 offset:4096
    ds_read_b64_tr_b16 a[94:95], v31 offset:5120
    v_add_f32 v252, v252, v254
    s_waitcnt vmcnt(10) lgkmcnt(15)
    v_mfma_f32_32x32x16_bf16 v[160:175], a[168:171], v[80:83], v[160:175]
    ds_read_b64_tr_b16 a[196:197], v25 offset:53248
    ds_read_b64_tr_b16 a[198:199], v25 offset:55296
    buffer_load_dwordx4 v[124:127], v1, s[28:31], s4 offen offset:3072 sc1
    v_add_f32 v253, v253, v255
    v_mov_b32 v254, v252
    v_mov_b32 v255, v253
    v_mfma_f32_32x32x16_bf16 v[176:191], a[172:175], v[80:83], v[176:191]
    ds_read_b64_tr_b16 a[168:169], v22 offset:57344
    ds_read_b64_tr_b16 a[170:171], v22 offset:59392
    v_mov_b32 v247, 0
    v_permlane32_swap_b32 v252, v254
    v_permlane32_swap_b32 v253, v255
    s_waitcnt lgkmcnt(15)
    v_mfma_f32_32x32x16_bf16 v[192:207], a[176:179], v[80:83], v[192:207]
    ds_read_b64_tr_b16 a[172:173], v23 offset:57344
    ds_read_b64_tr_b16 a[174:175], v23 offset:59392
    s_waitcnt lgkmcnt(6)
    s_add_u32 m0, s0, 131072
    s_add_u32 s3, s2, 196608
    buffer_load_dwordx4 v20, s[24:27], s3 offen lds
    v_mfma_f32_32x32x16_bf16 v[208:223], a[180:183], v[80:83], v[208:223]
    ds_read_b64_tr_b16 a[176:177], v24 offset:57344
    ds_read_b64_tr_b16 a[178:179], v24 offset:59392
    s_add_u32 s4, s60, 24576
    buffer_load_dwordx4 v[128:131], v1, s[28:31], s4 offen offset:0 sc1
    buffer_load_dwordx4 v15, s[24:27], s3 offen offset:1024 lds
    s_waitcnt vmcnt(13)
    v_mfma_f32_32x32x16_bf16 v[160:175], a[184:187], v[84:87], v[160:175]
    ds_read_b64_tr_b16 a[180:181], v25 offset:57344
    ds_read_b64_tr_b16 a[182:183], v25 offset:59392
    buffer_load_dwordx4 v21, s[24:27], s3 offen offset:2048 lds
    buffer_load_dwordx4 v248, s[24:27], s3 offen offset:3072 lds
    v_add_f32 v252, v252, v254
    v_add_f32 v253, v253, v255
    v_mfma_f32_32x32x16_bf16 v[176:191], a[188:191], v[84:87], v[176:191]
    ds_read_b64_tr_b16 a[184:185], v22 offset:61440
    ds_read_b64_tr_b16 a[186:187], v22 offset:63488
    s_add_u32 m0, s0, 135168
    s_add_u32 s3, s2, 229376
    buffer_load_dwordx4 v20, s[24:27], s3 offen lds
    s_waitcnt lgkmcnt(10)
    v_mfma_f32_32x32x16_bf16 v[192:207], a[192:195], v[84:87], v[192:207]
    ds_read_b64_tr_b16 a[188:189], v23 offset:61440
    ds_read_b64_tr_b16 a[190:191], v23 offset:63488
    buffer_load_dwordx4 v[132:135], v1, s[28:31], s4 offen offset:1024 sc1
    buffer_load_dwordx4 v15, s[24:27], s3 offen offset:1024 lds
    v_mul_f32 v252, 0xbb000000, v252
    v_mul_f32 v253, 0x3b000000, v253
    v_mfma_f32_32x32x16_bf16 v[208:223], a[196:199], v[84:87], v[208:223]
    ds_read_b64_tr_b16 a[192:193], v24 offset:61440
    ds_read_b64_tr_b16 a[194:195], v24 offset:63488
    v_fma_f32 v253, -v252, v252, v253
    v_max_f32 v253, 0, v253
    v_add_f32 v254, 0x3727c5ac, v253
    s_waitcnt vmcnt(17) lgkmcnt(10)
    v_mfma_f32_32x32x16_bf16 v[160:175], a[168:171], v[88:91], v[160:175]
    ds_read_b64_tr_b16 a[196:197], v25 offset:61440
    ds_read_b64_tr_b16 a[198:199], v25 offset:63488
    v_rsq_f32 v255, v254
    v_cvt_pk_bf16_f32 v17, v252, v252
    v_mul_f32 v253, v253, v255
    v_mfma_f32_32x32x16_bf16 v[176:191], a[172:175], v[88:91], v[176:191]
    v_add_u32 v22, 0x10000, v22
    ds_read_b64_tr_b16 a[168:169], v22 offset:0
    ds_read_b64_tr_b16 a[170:171], v22 offset:2048
    buffer_load_dwordx4 v[136:139], v1, s[28:31], s4 offen offset:2048 sc1
    v_mul_f32 v253, v253, v255
    v_add_f32 v253, 0x3727c5ac, v253
    s_waitcnt lgkmcnt(10)
    v_mfma_f32_32x32x16_bf16 v[192:207], a[176:179], v[88:91], v[192:207]
    v_add_u32 v23, 0x10000, v23
    ds_read_b64_tr_b16 a[172:173], v23 offset:0
    ds_read_b64_tr_b16 a[174:175], v23 offset:2048
    v_rsq_f32 v27, v253
    v_mul_f32 v254, v254, v255
    v_and_b32 v17, 0xffff0000, v17
    v_mfma_f32_32x32x16_bf16 v[208:223], a[180:183], v[88:91], v[208:223]
    v_add_u32 v24, 0x10000, v24
    ds_read_b64_tr_b16 a[176:177], v24 offset:0
    ds_read_b64_tr_b16 a[178:179], v24 offset:2048
    v_mul_f32 v255, v255, v27
    v_mul_f32 v253, v253, v27
    v_mul_f32 v26, v253, v254
    s_waitcnt vmcnt(17) lgkmcnt(10)
    v_mfma_f32_32x32x16_bf16 v[160:175], a[184:187], v[92:95], v[160:175]
    v_add_u32 v25, 0x10000, v25
    ds_read_b64_tr_b16 a[180:181], v25 offset:0
    ds_read_b64_tr_b16 a[182:183], v25 offset:2048
    buffer_load_dwordx4 v[140:143], v1, s[28:31], s4 offen offset:3072 sc1
    v_sub_f32 v17, v252, v17
    v_cvt_pk_bf16_f32 v244, v252, v17
    v_cvt_pk_bf16_f32 v245, v252, v26
    v_mfma_f32_32x32x16_bf16 v[176:191], a[188:191], v[92:95], v[176:191]
    ds_read_b64_tr_b16 a[184:185], v22 offset:4096
    ds_read_b64_tr_b16 a[186:187], v22 offset:6144
    v_and_b32 v17, 0xffff0000, v245
    v_sub_f32 v17, v26, v17
    v_cvt_pk_bf16_f32 v246, v17, 0
    s_waitcnt lgkmcnt(10)
    v_mfma_f32_32x32x16_bf16 v[192:207], a[192:195], v[92:95], v[192:207]
    ds_read_b64_tr_b16 a[188:189], v23 offset:4096
    ds_read_b64_tr_b16 a[190:191], v23 offset:6144
    v_cndmask_b32 v244, 0, v244, s[96:97]
    v_cndmask_b32 v245, 0, v245, s[96:97]
    v_cndmask_b32 v246, 0, v246, s[96:97]
    v_mul_f32 v18, 0xc0135761, v255
    v_mfma_f32_32x32x16_bf16 v[208:223], a[196:199], v[92:95], v[208:223]
    ds_read_b64_tr_b16 a[192:193], v24 offset:4096
    ds_read_b64_tr_b16 a[194:195], v24 offset:6144
    s_add_u32 s4, s60, 28672
    buffer_load_dwordx4 v[144:147], v1, s[28:31], s4 offen offset:0 sc1
    v_mul_f32 v254, v255, v255
    s_waitcnt vmcnt(18) lgkmcnt(10)
    v_mfma_f32_32x32x16_bf16 v[160:175], a[168:171], v[96:99], v[160:175]
    ds_read_b64_tr_b16 a[196:197], v25 offset:4096
    ds_read_b64_tr_b16 a[198:199], v25 offset:6144
    v_mul_f32 v254, 0x3d372713, v254
    v_mul_f32 v19, v18, v254
    v_mfma_f32_32x32x16_bf16 v[176:191], a[172:175], v[96:99], v[176:191]
    ds_read_b64_tr_b16 a[168:169], v22 offset:8192
    ds_read_b64_tr_b16 a[170:171], v22 offset:10240
    s_waitcnt lgkmcnt(10)
    v_mfma_f32_32x32x16_bf16 v[192:207], a[176:179], v[96:99], v[192:207]
    ds_read_b64_tr_b16 a[172:173], v23 offset:8192
    ds_read_b64_tr_b16 a[174:175], v23 offset:10240
    buffer_load_dwordx4 v[148:151], v1, s[28:31], s4 offen offset:1024 sc1
    v_mfma_f32_32x32x16_bf16 v[208:223], a[180:183], v[96:99], v[208:223]
    ds_read_b64_tr_b16 a[176:177], v24 offset:8192
    ds_read_b64_tr_b16 a[178:179], v24 offset:10240
    s_waitcnt vmcnt(18) lgkmcnt(10)
    v_mfma_f32_32x32x16_bf16 v[160:175], a[184:187], v[100:103], v[160:175]
    ds_read_b64_tr_b16 a[180:181], v25 offset:8192
    ds_read_b64_tr_b16 a[182:183], v25 offset:10240
    v_mfma_f32_32x32x16_bf16 v[176:191], a[188:191], v[100:103], v[176:191]
    ds_read_b64_tr_b16 a[184:185], v22 offset:12288
    ds_read_b64_tr_b16 a[186:187], v22 offset:14336
    buffer_load_dwordx4 v[152:155], v1, s[28:31], s4 offen offset:2048 sc1
    s_waitcnt lgkmcnt(10)
    v_mfma_f32_32x32x16_bf16 v[192:207], a[192:195], v[100:103], v[192:207]
    ds_read_b64_tr_b16 a[188:189], v23 offset:12288
    ds_read_b64_tr_b16 a[190:191], v23 offset:14336
    v_mfma_f32_32x32x16_bf16 v[208:223], a[196:199], v[100:103], v[208:223]
    ds_read_b64_tr_b16 a[192:193], v24 offset:12288
    ds_read_b64_tr_b16 a[194:195], v24 offset:14336
    s_waitcnt vmcnt(18) lgkmcnt(10)
    v_mfma_f32_32x32x16_bf16 v[160:175], a[168:171], v[104:107], v[160:175]
    ds_read_b64_tr_b16 a[196:197], v25 offset:12288
    ds_read_b64_tr_b16 a[198:199], v25 offset:14336
    buffer_load_dwordx4 v[156:159], v1, s[28:31], s4 offen offset:3072 sc1
    v_mfma_f32_32x32x16_bf16 v[176:191], a[172:175], v[104:107], v[176:191]
    ds_read_b64_tr_b16 a[168:169], v22 offset:16384
    ds_read_b64_tr_b16 a[170:171], v22 offset:18432
    s_waitcnt lgkmcnt(10)
    v_mfma_f32_32x32x16_bf16 v[192:207], a[176:179], v[104:107], v[192:207]
    ds_read_b64_tr_b16 a[172:173], v23 offset:16384
    ds_read_b64_tr_b16 a[174:175], v23 offset:18432
    v_mfma_f32_32x32x16_bf16 v[208:223], a[180:183], v[104:107], v[208:223]
    ds_read_b64_tr_b16 a[176:177], v24 offset:16384
    ds_read_b64_tr_b16 a[178:179], v24 offset:18432
    s_waitcnt vmcnt(18) lgkmcnt(10)
    v_mfma_f32_32x32x16_bf16 v[160:175], a[184:187], v[108:111], v[160:175]
    ds_read_b64_tr_b16 a[180:181], v25 offset:16384
    ds_read_b64_tr_b16 a[182:183], v25 offset:18432
    v_mfma_f32_32x32x16_bf16 v[176:191], a[188:191], v[108:111], v[176:191]
    ds_read_b64_tr_b16 a[184:185], v22 offset:20480
    ds_read_b64_tr_b16 a[186:187], v22 offset:22528
    s_waitcnt lgkmcnt(10)
    v_mfma_f32_32x32x16_bf16 v[192:207], a[192:195], v[108:111], v[192:207]
    ds_read_b64_tr_b16 a[188:189], v23 offset:20480
    ds_read_b64_tr_b16 a[190:191], v23 offset:22528
    v_mfma_f32_32x32x16_bf16 v[208:223], a[196:199], v[108:111], v[208:223]
    ds_read_b64_tr_b16 a[192:193], v24 offset:20480
    ds_read_b64_tr_b16 a[194:195], v24 offset:22528
    s_waitcnt vmcnt(17) lgkmcnt(10)
    v_mfma_f32_32x32x16_bf16 v[160:175], a[168:171], v[112:115], v[160:175]
    ds_read_b64_tr_b16 a[196:197], v25 offset:20480
    ds_read_b64_tr_b16 a[198:199], v25 offset:22528
    v_mfma_f32_32x32x16_bf16 v[176:191], a[172:175], v[112:115], v[176:191]
    ds_read_b64_tr_b16 a[168:169], v22 offset:24576
    ds_read_b64_tr_b16 a[170:171], v22 offset:26624
    s_waitcnt lgkmcnt(10)
    v_mfma_f32_32x32x16_bf16 v[192:207], a[176:179], v[112:115], v[192:207]
    ds_read_b64_tr_b16 a[172:173], v23 offset:24576
    ds_read_b64_tr_b16 a[174:175], v23 offset:26624
    v_mfma_f32_32x32x16_bf16 v[208:223], a[180:183], v[112:115], v[208:223]
    ds_read_b64_tr_b16 a[176:177], v24 offset:24576
    ds_read_b64_tr_b16 a[178:179], v24 offset:26624
    s_waitcnt vmcnt(16) lgkmcnt(10)
    v_mfma_f32_32x32x16_bf16 v[160:175], a[184:187], v[116:119], v[160:175]
    ds_read_b64_tr_b16 a[180:181], v25 offset:24576
    ds_read_b64_tr_b16 a[182:183], v25 offset:26624
    s_waitcnt vmcnt(6)
    ds_read_b64_tr_b16 a[96:97], v30 offset:0
    ds_read_b64_tr_b16 a[98:99], v30 offset:1024
    v_mfma_f32_32x32x16_bf16 v[176:191], a[188:191], v[116:119], v[176:191]
    ds_read_b64_tr_b16 a[184:185], v22 offset:28672
    ds_read_b64_tr_b16 a[186:187], v22 offset:30720
    ds_read_b64_tr_b16 a[100:101], v31 offset:0
    ds_read_b64_tr_b16 a[102:103], v31 offset:1024
    s_waitcnt lgkmcnt(14)
    v_mfma_f32_32x32x16_bf16 v[192:207], a[192:195], v[116:119], v[192:207]
    ds_read_b64_tr_b16 a[188:189], v23 offset:28672
    ds_read_b64_tr_b16 a[190:191], v23 offset:30720
    ds_read_b64_tr_b16 a[104:105], v30 offset:2048
    ds_read_b64_tr_b16 a[106:107], v30 offset:3072
    v_mfma_f32_32x32x16_bf16 v[208:223], a[196:199], v[116:119], v[208:223]
    ds_read_b64_tr_b16 a[192:193], v24 offset:28672
    ds_read_b64_tr_b16 a[194:195], v24 offset:30720
    ds_read_b64_tr_b16 a[108:109], v31 offset:2048
    ds_read_b64_tr_b16 a[110:111], v31 offset:3072
    s_waitcnt lgkmcnt(15)
    v_mfma_f32_32x32x16_bf16 v[160:175], a[168:171], v[120:123], v[160:175]
    ds_read_b64_tr_b16 a[196:197], v25 offset:28672
    ds_read_b64_tr_b16 a[198:199], v25 offset:30720
    ds_read_b64_tr_b16 a[112:113], v30 offset:4096
    ds_read_b64_tr_b16 a[114:115], v30 offset:5120
    v_mfma_f32_32x32x16_bf16 v[176:191], a[172:175], v[120:123], v[176:191]
    ds_read_b64_tr_b16 a[168:169], v22 offset:32768
    ds_read_b64_tr_b16 a[170:171], v22 offset:34816
    ds_read_b64_tr_b16 a[116:117], v31 offset:4096
    ds_read_b64_tr_b16 a[118:119], v31 offset:5120
    s_waitcnt lgkmcnt(15)
    v_mfma_f32_32x32x16_bf16 v[192:207], a[176:179], v[120:123], v[192:207]
    ds_read_b64_tr_b16 a[172:173], v23 offset:32768
    ds_read_b64_tr_b16 a[174:175], v23 offset:34816
    s_waitcnt lgkmcnt(2)
    s_add_u32 m0, s0, 131072
    s_add_u32 s3, s2, 245760
    buffer_load_dwordx4 v20, s[24:27], s3 offen lds
    v_mfma_f32_32x32x16_bf16 v[208:223], a[180:183], v[120:123], v[208:223]
    ds_read_b64_tr_b16 a[176:177], v24 offset:32768
    ds_read_b64_tr_b16 a[178:179], v24 offset:34816
    buffer_load_dwordx4 v15, s[24:27], s3 offen offset:1024 lds
    v_mfma_f32_32x32x16_bf16 v[160:175], a[184:187], v[124:127], v[160:175]
    ds_read_b64_tr_b16 a[180:181], v25 offset:32768
    ds_read_b64_tr_b16 a[182:183], v25 offset:34816
    buffer_load_dwordx4 v21, s[24:27], s3 offen offset:2048 lds
    v_mfma_f32_32x32x16_bf16 v[176:191], a[188:191], v[124:127], v[176:191]
    ds_read_b64_tr_b16 a[184:185], v22 offset:36864
    ds_read_b64_tr_b16 a[186:187], v22 offset:38912
    buffer_load_dwordx4 v248, s[24:27], s3 offen offset:3072 lds
    v_mfma_f32_32x32x16_bf16 v[192:207], a[192:195], v[124:127], v[192:207]
    ds_read_b64_tr_b16 a[188:189], v23 offset:36864
    ds_read_b64_tr_b16 a[190:191], v23 offset:38912
    s_add_u32 m0, s0, 135168
    s_add_u32 s3, s2, 278528
    buffer_load_dwordx4 v20, s[24:27], s3 offen lds
    v_mfma_f32_32x32x16_bf16 v[208:223], a[196:199], v[124:127], v[208:223]
    ds_read_b64_tr_b16 a[192:193], v24 offset:36864
    ds_read_b64_tr_b16 a[194:195], v24 offset:38912
    buffer_load_dwordx4 v15, s[24:27], s3 offen offset:1024 lds
    s_waitcnt lgkmcnt(10)
    v_mfma_f32_32x32x16_bf16 v[160:175], a[168:171], v[128:131], v[160:175]
    ds_read_b64_tr_b16 a[196:197], v25 offset:36864
    ds_read_b64_tr_b16 a[198:199], v25 offset:38912
    v_mfma_f32_32x32x16_bf16 v[176:191], a[172:175], v[128:131], v[176:191]
    ds_read_b64_tr_b16 a[168:169], v22 offset:40960
    ds_read_b64_tr_b16 a[170:171], v22 offset:43008
    s_waitcnt lgkmcnt(10)
    v_mfma_f32_32x32x16_bf16 v[192:207], a[176:179], v[128:131], v[192:207]
    ds_read_b64_tr_b16 a[172:173], v23 offset:40960
    ds_read_b64_tr_b16 a[174:175], v23 offset:43008
    v_mfma_f32_32x32x16_bf16 v[208:223], a[180:183], v[128:131], v[208:223]
    ds_read_b64_tr_b16 a[176:177], v24 offset:40960
    ds_read_b64_tr_b16 a[178:179], v24 offset:43008
    s_waitcnt lgkmcnt(10)
    v_mfma_f32_32x32x16_bf16 v[160:175], a[184:187], v[132:135], v[160:175]
    ds_read_b64_tr_b16 a[180:181], v25 offset:40960
    ds_read_b64_tr_b16 a[182:183], v25 offset:43008
    v_mfma_f32_32x32x16_bf16 v[176:191], a[188:191], v[132:135], v[176:191]
    ds_read_b64_tr_b16 a[184:185], v22 offset:45056
    ds_read_b64_tr_b16 a[186:187], v22 offset:47104
    s_waitcnt lgkmcnt(10)
    v_mfma_f32_32x32x16_bf16 v[192:207], a[192:195], v[132:135], v[192:207]
    ds_read_b64_tr_b16 a[188:189], v23 offset:45056
    ds_read_b64_tr_b16 a[190:191], v23 offset:47104
    v_mfma_f32_32x32x16_bf16 v[208:223], a[196:199], v[132:135], v[208:223]
    ds_read_b64_tr_b16 a[192:193], v24 offset:45056
    ds_read_b64_tr_b16 a[194:195], v24 offset:47104
    s_waitcnt vmcnt(11) lgkmcnt(10)
    v_mfma_f32_32x32x16_bf16 v[160:175], a[168:171], v[136:139], v[160:175]
    ds_read_b64_tr_b16 a[196:197], v25 offset:45056
    ds_read_b64_tr_b16 a[198:199], v25 offset:47104
    v_mfma_f32_32x32x16_bf16 v[176:191], a[172:175], v[136:139], v[176:191]
    ds_read_b64_tr_b16 a[168:169], v22 offset:49152
    ds_read_b64_tr_b16 a[170:171], v22 offset:51200
    s_waitcnt lgkmcnt(10)
    v_mfma_f32_32x32x16_bf16 v[192:207], a[176:179], v[136:139], v[192:207]
    ds_read_b64_tr_b16 a[172:173], v23 offset:49152
    ds_read_b64_tr_b16 a[174:175], v23 offset:51200
    v_mfma_f32_32x32x16_bf16 v[208:223], a[180:183], v[136:139], v[208:223]
    ds_read_b64_tr_b16 a[176:177], v24 offset:49152
    ds_read_b64_tr_b16 a[178:179], v24 offset:51200
    s_waitcnt vmcnt(10) lgkmcnt(10)
    v_mfma_f32_32x32x16_bf16 v[160:175], a[184:187], v[140:143], v[160:175]
    ds_read_b64_tr_b16 a[180:181], v25 offset:49152
    ds_read_b64_tr_b16 a[182:183], v25 offset:51200
    v_mfma_f32_32x32x16_bf16 v[176:191], a[188:191], v[140:143], v[176:191]
    ds_read_b64_tr_b16 a[184:185], v22 offset:53248
    ds_read_b64_tr_b16 a[186:187], v22 offset:55296
    s_waitcnt lgkmcnt(10)
    v_mfma_f32_32x32x16_bf16 v[192:207], a[192:195], v[140:143], v[192:207]
    ds_read_b64_tr_b16 a[188:189], v23 offset:53248
    ds_read_b64_tr_b16 a[190:191], v23 offset:55296
    v_mfma_f32_32x32x16_bf16 v[208:223], a[196:199], v[140:143], v[208:223]
    ds_read_b64_tr_b16 a[192:193], v24 offset:53248
    ds_read_b64_tr_b16 a[194:195], v24 offset:55296
    s_waitcnt vmcnt(9) lgkmcnt(10)
    v_mfma_f32_32x32x16_bf16 v[160:175], a[168:171], v[144:147], v[160:175]
    ds_read_b64_tr_b16 a[196:197], v25 offset:53248
    ds_read_b64_tr_b16 a[198:199], v25 offset:55296
    v_mfma_f32_32x32x16_bf16 v[176:191], a[172:175], v[144:147], v[176:191]
    ds_read_b64_tr_b16 a[168:169], v22 offset:57344
    ds_read_b64_tr_b16 a[170:171], v22 offset:59392
    s_waitcnt lgkmcnt(10)
    v_mfma_f32_32x32x16_bf16 v[192:207], a[176:179], v[144:147], v[192:207]
    ds_read_b64_tr_b16 a[172:173], v23 offset:57344
    ds_read_b64_tr_b16 a[174:175], v23 offset:59392
    v_mfma_f32_32x32x16_bf16 v[208:223], a[180:183], v[144:147], v[208:223]
    ds_read_b64_tr_b16 a[176:177], v24 offset:57344
    ds_read_b64_tr_b16 a[178:179], v24 offset:59392
    s_waitcnt vmcnt(8) lgkmcnt(10)
    v_mfma_f32_32x32x16_bf16 v[160:175], a[184:187], v[148:151], v[160:175]
    ds_read_b64_tr_b16 a[180:181], v25 offset:57344
    ds_read_b64_tr_b16 a[182:183], v25 offset:59392
    v_mfma_f32_32x32x16_bf16 v[176:191], a[188:191], v[148:151], v[176:191]
    ds_read_b64_tr_b16 a[184:185], v22 offset:61440
    ds_read_b64_tr_b16 a[186:187], v22 offset:63488
    s_waitcnt lgkmcnt(10)
    v_mfma_f32_32x32x16_bf16 v[192:207], a[192:195], v[148:151], v[192:207]
    ds_read_b64_tr_b16 a[188:189], v23 offset:61440
    ds_read_b64_tr_b16 a[190:191], v23 offset:63488
    v_mfma_f32_32x32x16_bf16 v[208:223], a[196:199], v[148:151], v[208:223]
    ds_read_b64_tr_b16 a[192:193], v24 offset:61440
    ds_read_b64_tr_b16 a[194:195], v24 offset:63488
    s_waitcnt vmcnt(7) lgkmcnt(10)
    v_mfma_f32_32x32x16_bf16 v[160:175], a[168:171], v[152:155], v[160:175]
    ds_read_b64_tr_b16 a[196:197], v25 offset:61440
    ds_read_b64_tr_b16 a[198:199], v25 offset:63488
    s_waitcnt vmcnt(0)
    ds_read_b64_tr_b16 a[120:121], v30 offset:0
    ds_read_b64_tr_b16 a[122:123], v30 offset:1024
    v_mfma_f32_32x32x16_bf16 v[176:191], a[172:175], v[152:155], v[176:191]
    ds_read_b128 a[168:171], v14 offset:0
    ds_read_b64_tr_b16 a[124:125], v31 offset:0
    ds_read_b64_tr_b16 a[126:127], v31 offset:1024
    s_waitcnt lgkmcnt(13)
    v_mfma_f32_32x32x16_bf16 v[192:207], a[176:179], v[152:155], v[192:207]
    ds_read_b128 a[172:175], v14 offset:1024
    ds_read_b64_tr_b16 a[128:129], v30 offset:2048
    ds_read_b64_tr_b16 a[130:131], v30 offset:3072
    v_mfma_f32_32x32x16_bf16 v[208:223], a[180:183], v[152:155], v[208:223]
    ds_read_b128 a[176:179], v14 offset:8192
    ds_read_b64_tr_b16 a[132:133], v31 offset:2048
    ds_read_b64_tr_b16 a[134:135], v31 offset:3072
    s_waitcnt lgkmcnt(15)
    v_mfma_f32_32x32x16_bf16 v[160:175], a[184:187], v[156:159], v[160:175]
    ds_read_b128 a[180:183], v14 offset:9216
    ds_read_b64_tr_b16 a[136:137], v30 offset:4096
    ds_read_b64_tr_b16 a[138:139], v30 offset:5120
    v_mfma_f32_32x32x16_bf16 v[176:191], a[188:191], v[156:159], v[176:191]
    ds_read_b64_tr_b16 a[140:141], v31 offset:4096
    ds_read_b64_tr_b16 a[142:143], v31 offset:5120
    s_waitcnt lgkmcnt(15)
    v_mfma_f32_32x32x16_bf16 v[192:207], a[192:195], v[156:159], v[192:207]
    s_waitcnt lgkmcnt(0)
    s_add_u32 m0, s0, 131072
    s_add_u32 s3, s2, 294912
    buffer_load_dwordx4 v20, s[24:27], s3 offen lds
    v_mfma_f32_32x32x16_bf16 v[208:223], a[196:199], v[156:159], v[208:223]
    buffer_load_dwordx4 v15, s[24:27], s3 offen offset:1024 lds
    v_mfma_f32_32x32x16_bf16 v[160:175], a[168:171], v[244:247], v[160:175]
    buffer_load_dwordx4 v21, s[24:27], s3 offen offset:2048 lds
    v_mfma_f32_32x32x16_bf16 v[176:191], a[172:175], v[244:247], v[176:191]
    buffer_load_dwordx4 v248, s[24:27], s3 offen offset:3072 lds
    v_mfma_f32_32x32x16_bf16 v[192:207], a[176:179], v[244:247], v[192:207]
    s_add_u32 m0, s0, 135168
    s_add_u32 s3, s2, 327680
    buffer_load_dwordx4 v20, s[24:27], s3 offen lds
    v_mfma_f32_32x32x16_bf16 v[208:223], a[180:183], v[244:247], v[208:223]
    buffer_load_dwordx4 v15, s[24:27], s3 offen offset:1024 lds
    s_waitcnt lgkmcnt(0)
    s_barrier
    s_lshl_b32 s54, s44, 14
    v_pk_mul_f32 v[252:253], v[160:161], v[160:161]
    v_pk_mul_f32 v[254:255], v[162:163], v[162:163]
    v_pk_fma_f32 v[252:253], v[252:253], v[18:19], v[18:19] op_sel:[0,1,0] op_sel_hi:[1,1,0]
    v_pk_fma_f32 v[254:255], v[254:255], v[18:19], v[18:19] op_sel:[0,1,0] op_sel_hi:[1,1,0]
    v_pk_mul_f32 v[252:253], v[252:253], v[160:161]
    v_pk_mul_f32 v[254:255], v[254:255], v[162:163]
    s_add_u32 m0, s54, 0
    s_add_u32 s3, s2, 344064
    buffer_load_dwordx4 v20, s[24:27], s3 offen lds
    v_exp_f32 v252, v252
    v_exp_f32 v253, v253
    v_exp_f32 v254, v254
    v_exp_f32 v255, v255
    v_pk_fma_f32 v[252:253], v[252:253], v[26:27], v[26:27] op_sel_hi:[1,0,0]
    v_pk_fma_f32 v[254:255], v[254:255], v[26:27], v[26:27] op_sel_hi:[1,0,0]
    v_rcp_f32 v252, v252
    v_rcp_f32 v253, v253
    v_rcp_f32 v254, v254
    v_rcp_f32 v255, v255
    v_pk_mul_f32 v[252:253], v[252:253], v[160:161]
    v_pk_mul_f32 v[254:255], v[254:255], v[162:163]
    v_cvt_pk_bf16_f32 v160, v252, v253
    v_cvt_pk_bf16_f32 v161, v254, v255
    v_pk_mul_f32 v[252:253], v[164:165], v[164:165]
    v_pk_mul_f32 v[254:255], v[166:167], v[166:167]
    v_pk_fma_f32 v[252:253], v[252:253], v[18:19], v[18:19] op_sel:[0,1,0] op_sel_hi:[1,1,0]
    v_pk_fma_f32 v[254:255], v[254:255], v[18:19], v[18:19] op_sel:[0,1,0] op_sel_hi:[1,1,0]
    v_pk_mul_f32 v[252:253], v[252:253], v[164:165]
    v_pk_mul_f32 v[254:255], v[254:255], v[166:167]
    v_exp_f32 v252, v252
    v_exp_f32 v253, v253
    v_exp_f32 v254, v254
    v_exp_f32 v255, v255
    v_pk_fma_f32 v[252:253], v[252:253], v[26:27], v[26:27] op_sel_hi:[1,0,0]
    v_pk_fma_f32 v[254:255], v[254:255], v[26:27], v[26:27] op_sel_hi:[1,0,0]
    v_rcp_f32 v252, v252
    v_rcp_f32 v253, v253
    v_rcp_f32 v254, v254
    v_rcp_f32 v255, v255
    v_pk_mul_f32 v[252:253], v[252:253], v[164:165]
    v_pk_mul_f32 v[254:255], v[254:255], v[166:167]
    v_cvt_pk_bf16_f32 v162, v252, v253
    v_cvt_pk_bf16_f32 v163, v254, v255
    v_pk_mul_f32 v[252:253], v[168:169], v[168:169]
    v_pk_mul_f32 v[254:255], v[170:171], v[170:171]
    v_pk_fma_f32 v[252:253], v[252:253], v[18:19], v[18:19] op_sel:[0,1,0] op_sel_hi:[1,1,0]
    v_pk_fma_f32 v[254:255], v[254:255], v[18:19], v[18:19] op_sel:[0,1,0] op_sel_hi:[1,1,0]
    v_pk_mul_f32 v[252:253], v[252:253], v[168:169]
    v_pk_mul_f32 v[254:255], v[254:255], v[170:171]
    buffer_load_dwordx4 v15, s[24:27], s3 offen offset:1024 lds
    v_exp_f32 v252, v252
    v_exp_f32 v253, v253
    v_exp_f32 v254, v254
    v_exp_f32 v255, v255
    v_pk_fma_f32 v[252:253], v[252:253], v[26:27], v[26:27] op_sel_hi:[1,0,0]
    v_pk_fma_f32 v[254:255], v[254:255], v[26:27], v[26:27] op_sel_hi:[1,0,0]
    v_rcp_f32 v252, v252
    v_rcp_f32 v253, v253
    v_rcp_f32 v254, v254
    v_rcp_f32 v255, v255
    v_pk_mul_f32 v[252:253], v[252:253], v[168:169]
    v_pk_mul_f32 v[254:255], v[254:255], v[170:171]
    v_cvt_pk_bf16_f32 v164, v252, v253
    v_cvt_pk_bf16_f32 v165, v254, v255
    v_pk_mul_f32 v[252:253], v[172:173], v[172:173]
    v_pk_mul_f32 v[254:255], v[174:175], v[174:175]
    v_pk_fma_f32 v[252:253], v[252:253], v[18:19], v[18:19] op_sel:[0,1,0] op_sel_hi:[1,1,0]
    v_pk_fma_f32 v[254:255], v[254:255], v[18:19], v[18:19] op_sel:[0,1,0] op_sel_hi:[1,1,0]
    v_pk_mul_f32 v[252:253], v[252:253], v[172:173]
    v_pk_mul_f32 v[254:255], v[254:255], v[174:175]
    v_exp_f32 v252, v252
    v_exp_f32 v253, v253
    v_exp_f32 v254, v254
    v_exp_f32 v255, v255
    v_pk_fma_f32 v[252:253], v[252:253], v[26:27], v[26:27] op_sel_hi:[1,0,0]
    v_pk_fma_f32 v[254:255], v[254:255], v[26:27], v[26:27] op_sel_hi:[1,0,0]
    v_rcp_f32 v252, v252
    v_rcp_f32 v253, v253
    v_rcp_f32 v254, v254
    v_rcp_f32 v255, v255
    v_pk_mul_f32 v[252:253], v[252:253], v[172:173]
    v_pk_mul_f32 v[254:255], v[254:255], v[174:175]
    v_cvt_pk_bf16_f32 v166, v252, v253
    v_cvt_pk_bf16_f32 v167, v254, v255
    buffer_store_dwordx4 v[160:163], v1, s[28:31], s49 offen offset:0 sc1
    buffer_store_dwordx4 v[164:167], v1, s[28:31], s49 offen offset:1024 sc1
    v_pk_mul_f32 v[252:253], v[176:177], v[176:177]
    v_pk_mul_f32 v[254:255], v[178:179], v[178:179]
    v_pk_fma_f32 v[252:253], v[252:253], v[18:19], v[18:19] op_sel:[0,1,0] op_sel_hi:[1,1,0]
    v_pk_fma_f32 v[254:255], v[254:255], v[18:19], v[18:19] op_sel:[0,1,0] op_sel_hi:[1,1,0]
    v_pk_mul_f32 v[252:253], v[252:253], v[176:177]
    v_pk_mul_f32 v[254:255], v[254:255], v[178:179]
    buffer_load_dwordx4 v21, s[24:27], s3 offen offset:2048 lds
    v_exp_f32 v252, v252
    v_exp_f32 v253, v253
    v_exp_f32 v254, v254
    v_exp_f32 v255, v255
    v_pk_fma_f32 v[252:253], v[252:253], v[26:27], v[26:27] op_sel_hi:[1,0,0]
    v_pk_fma_f32 v[254:255], v[254:255], v[26:27], v[26:27] op_sel_hi:[1,0,0]
    v_rcp_f32 v252, v252
    v_rcp_f32 v253, v253
    v_rcp_f32 v254, v254
    v_rcp_f32 v255, v255
    v_pk_mul_f32 v[252:253], v[252:253], v[176:177]
    v_pk_mul_f32 v[254:255], v[254:255], v[178:179]
    v_cvt_pk_bf16_f32 v176, v252, v253
    v_cvt_pk_bf16_f32 v177, v254, v255
    v_pk_mul_f32 v[252:253], v[180:181], v[180:181]
    v_pk_mul_f32 v[254:255], v[182:183], v[182:183]
    v_pk_fma_f32 v[252:253], v[252:253], v[18:19], v[18:19] op_sel:[0,1,0] op_sel_hi:[1,1,0]
    v_pk_fma_f32 v[254:255], v[254:255], v[18:19], v[18:19] op_sel:[0,1,0] op_sel_hi:[1,1,0]
    v_pk_mul_f32 v[252:253], v[252:253], v[180:181]
    v_pk_mul_f32 v[254:255], v[254:255], v[182:183]
    v_exp_f32 v252, v252
    v_exp_f32 v253, v253
    v_exp_f32 v254, v254
    v_exp_f32 v255, v255
    v_pk_fma_f32 v[252:253], v[252:253], v[26:27], v[26:27] op_sel_hi:[1,0,0]
    v_pk_fma_f32 v[254:255], v[254:255], v[26:27], v[26:27] op_sel_hi:[1,0,0]
    v_rcp_f32 v252, v252
    v_rcp_f32 v253, v253
    v_rcp_f32 v254, v254
    v_rcp_f32 v255, v255
    v_pk_mul_f32 v[252:253], v[252:253], v[180:181]
    v_pk_mul_f32 v[254:255], v[254:255], v[182:183]
    v_cvt_pk_bf16_f32 v178, v252, v253
    v_cvt_pk_bf16_f32 v179, v254, v255
    v_pk_mul_f32 v[252:253], v[184:185], v[184:185]
    v_pk_mul_f32 v[254:255], v[186:187], v[186:187]
    v_pk_fma_f32 v[252:253], v[252:253], v[18:19], v[18:19] op_sel:[0,1,0] op_sel_hi:[1,1,0]
    v_pk_fma_f32 v[254:255], v[254:255], v[18:19], v[18:19] op_sel:[0,1,0] op_sel_hi:[1,1,0]
    v_pk_mul_f32 v[252:253], v[252:253], v[184:185]
    v_pk_mul_f32 v[254:255], v[254:255], v[186:187]
    buffer_load_dwordx4 v248, s[24:27], s3 offen offset:3072 lds
    v_exp_f32 v252, v252
    v_exp_f32 v253, v253
    v_exp_f32 v254, v254
    v_exp_f32 v255, v255
    v_pk_fma_f32 v[252:253], v[252:253], v[26:27], v[26:27] op_sel_hi:[1,0,0]
    v_pk_fma_f32 v[254:255], v[254:255], v[26:27], v[26:27] op_sel_hi:[1,0,0]
    v_rcp_f32 v252, v252
    v_rcp_f32 v253, v253
    v_rcp_f32 v254, v254
    v_rcp_f32 v255, v255
    v_pk_mul_f32 v[252:253], v[252:253], v[184:185]
    v_pk_mul_f32 v[254:255], v[254:255], v[186:187]
    v_cvt_pk_bf16_f32 v180, v252, v253
    v_cvt_pk_bf16_f32 v181, v254, v255
    v_pk_mul_f32 v[252:253], v[188:189], v[188:189]
    v_pk_mul_f32 v[254:255], v[190:191], v[190:191]
    v_pk_fma_f32 v[252:253], v[252:253], v[18:19], v[18:19] op_sel:[0,1,0] op_sel_hi:[1,1,0]
    v_pk_fma_f32 v[254:255], v[254:255], v[18:19], v[18:19] op_sel:[0,1,0] op_sel_hi:[1,1,0]
    v_pk_mul_f32 v[252:253], v[252:253], v[188:189]
    v_pk_mul_f32 v[254:255], v[254:255], v[190:191]
    v_exp_f32 v252, v252
    v_exp_f32 v253, v253
    v_exp_f32 v254, v254
    v_exp_f32 v255, v255
    v_pk_fma_f32 v[252:253], v[252:253], v[26:27], v[26:27] op_sel_hi:[1,0,0]
    v_pk_fma_f32 v[254:255], v[254:255], v[26:27], v[26:27] op_sel_hi:[1,0,0]
    v_rcp_f32 v252, v252
    v_rcp_f32 v253, v253
    v_rcp_f32 v254, v254
    v_rcp_f32 v255, v255
    v_pk_mul_f32 v[252:253], v[252:253], v[188:189]
    v_pk_mul_f32 v[254:255], v[254:255], v[190:191]
    v_cvt_pk_bf16_f32 v182, v252, v253
    v_cvt_pk_bf16_f32 v183, v254, v255
    buffer_store_dwordx4 v[176:179], v1, s[28:31], s49 offen offset:2048 sc1
    buffer_store_dwordx4 v[180:183], v1, s[28:31], s49 offen offset:3072 sc1
    v_pk_mul_f32 v[252:253], v[192:193], v[192:193]
    v_pk_mul_f32 v[254:255], v[194:195], v[194:195]
    v_pk_fma_f32 v[252:253], v[252:253], v[18:19], v[18:19] op_sel:[0,1,0] op_sel_hi:[1,1,0]
    v_pk_fma_f32 v[254:255], v[254:255], v[18:19], v[18:19] op_sel:[0,1,0] op_sel_hi:[1,1,0]
    v_pk_mul_f32 v[252:253], v[252:253], v[192:193]
    v_pk_mul_f32 v[254:255], v[254:255], v[194:195]
    s_add_u32 m0, s54, 4096
    s_add_u32 s3, s2, 376832
    buffer_load_dwordx4 v20, s[24:27], s3 offen lds
    v_exp_f32 v252, v252
    v_exp_f32 v253, v253
    v_exp_f32 v254, v254
    v_exp_f32 v255, v255
    v_pk_fma_f32 v[252:253], v[252:253], v[26:27], v[26:27] op_sel_hi:[1,0,0]
    v_pk_fma_f32 v[254:255], v[254:255], v[26:27], v[26:27] op_sel_hi:[1,0,0]
    v_rcp_f32 v252, v252
    v_rcp_f32 v253, v253
    v_rcp_f32 v254, v254
    v_rcp_f32 v255, v255
    v_pk_mul_f32 v[252:253], v[252:253], v[192:193]
    v_pk_mul_f32 v[254:255], v[254:255], v[194:195]
    v_cvt_pk_bf16_f32 v192, v252, v253
    v_cvt_pk_bf16_f32 v193, v254, v255
    v_pk_mul_f32 v[252:253], v[196:197], v[196:197]
    v_pk_mul_f32 v[254:255], v[198:199], v[198:199]
    v_pk_fma_f32 v[252:253], v[252:253], v[18:19], v[18:19] op_sel:[0,1,0] op_sel_hi:[1,1,0]
    v_pk_fma_f32 v[254:255], v[254:255], v[18:19], v[18:19] op_sel:[0,1,0] op_sel_hi:[1,1,0]
    v_pk_mul_f32 v[252:253], v[252:253], v[196:197]
    v_pk_mul_f32 v[254:255], v[254:255], v[198:199]
    v_exp_f32 v252, v252
    v_exp_f32 v253, v253
    v_exp_f32 v254, v254
    v_exp_f32 v255, v255
    v_pk_fma_f32 v[252:253], v[252:253], v[26:27], v[26:27] op_sel_hi:[1,0,0]
    v_pk_fma_f32 v[254:255], v[254:255], v[26:27], v[26:27] op_sel_hi:[1,0,0]
    v_rcp_f32 v252, v252
    v_rcp_f32 v253, v253
    v_rcp_f32 v254, v254
    v_rcp_f32 v255, v255
    v_pk_mul_f32 v[252:253], v[252:253], v[196:197]
    v_pk_mul_f32 v[254:255], v[254:255], v[198:199]
    v_cvt_pk_bf16_f32 v194, v252, v253
    v_cvt_pk_bf16_f32 v195, v254, v255
    v_pk_mul_f32 v[252:253], v[200:201], v[200:201]
    v_pk_mul_f32 v[254:255], v[202:203], v[202:203]
    v_pk_fma_f32 v[252:253], v[252:253], v[18:19], v[18:19] op_sel:[0,1,0] op_sel_hi:[1,1,0]
    v_pk_fma_f32 v[254:255], v[254:255], v[18:19], v[18:19] op_sel:[0,1,0] op_sel_hi:[1,1,0]
    v_pk_mul_f32 v[252:253], v[252:253], v[200:201]
    v_pk_mul_f32 v[254:255], v[254:255], v[202:203]
    buffer_load_dwordx4 v15, s[24:27], s3 offen offset:1024 lds
    v_exp_f32 v252, v252
    v_exp_f32 v253, v253
    v_exp_f32 v254, v254
    v_exp_f32 v255, v255
    v_pk_fma_f32 v[252:253], v[252:253], v[26:27], v[26:27] op_sel_hi:[1,0,0]
    v_pk_fma_f32 v[254:255], v[254:255], v[26:27], v[26:27] op_sel_hi:[1,0,0]
    v_rcp_f32 v252, v252
    v_rcp_f32 v253, v253
    v_rcp_f32 v254, v254
    v_rcp_f32 v255, v255
    v_pk_mul_f32 v[252:253], v[252:253], v[200:201]
    v_pk_mul_f32 v[254:255], v[254:255], v[202:203]
    v_cvt_pk_bf16_f32 v196, v252, v253
    v_cvt_pk_bf16_f32 v197, v254, v255
    v_pk_mul_f32 v[252:253], v[204:205], v[204:205]
    v_pk_mul_f32 v[254:255], v[206:207], v[206:207]
    v_pk_fma_f32 v[252:253], v[252:253], v[18:19], v[18:19] op_sel:[0,1,0] op_sel_hi:[1,1,0]
    v_pk_fma_f32 v[254:255], v[254:255], v[18:19], v[18:19] op_sel:[0,1,0] op_sel_hi:[1,1,0]
    v_pk_mul_f32 v[252:253], v[252:253], v[204:205]
    v_pk_mul_f32 v[254:255], v[254:255], v[206:207]
    v_exp_f32 v252, v252
    v_exp_f32 v253, v253
    v_exp_f32 v254, v254
    v_exp_f32 v255, v255
    v_pk_fma_f32 v[252:253], v[252:253], v[26:27], v[26:27] op_sel_hi:[1,0,0]
    v_pk_fma_f32 v[254:255], v[254:255], v[26:27], v[26:27] op_sel_hi:[1,0,0]
    v_rcp_f32 v252, v252
    v_rcp_f32 v253, v253
    v_rcp_f32 v254, v254
    v_rcp_f32 v255, v255
    v_pk_mul_f32 v[252:253], v[252:253], v[204:205]
    v_pk_mul_f32 v[254:255], v[254:255], v[206:207]
    v_cvt_pk_bf16_f32 v198, v252, v253
    v_cvt_pk_bf16_f32 v199, v254, v255
    buffer_store_dwordx4 v[192:195], v1, s[28:31], s58 offen offset:0 sc1
    buffer_store_dwordx4 v[196:199], v1, s[28:31], s58 offen offset:1024 sc1
    v_pk_mul_f32 v[252:253], v[208:209], v[208:209]
    v_pk_mul_f32 v[254:255], v[210:211], v[210:211]
    v_pk_fma_f32 v[252:253], v[252:253], v[18:19], v[18:19] op_sel:[0,1,0] op_sel_hi:[1,1,0]
    v_pk_fma_f32 v[254:255], v[254:255], v[18:19], v[18:19] op_sel:[0,1,0] op_sel_hi:[1,1,0]
    v_pk_mul_f32 v[252:253], v[252:253], v[208:209]
    v_pk_mul_f32 v[254:255], v[254:255], v[210:211]
    buffer_load_dwordx4 v21, s[24:27], s3 offen offset:2048 lds
    v_exp_f32 v252, v252
    v_exp_f32 v253, v253
    v_exp_f32 v254, v254
    v_exp_f32 v255, v255
    v_pk_fma_f32 v[252:253], v[252:253], v[26:27], v[26:27] op_sel_hi:[1,0,0]
    v_pk_fma_f32 v[254:255], v[254:255], v[26:27], v[26:27] op_sel_hi:[1,0,0]
    v_rcp_f32 v252, v252
    v_rcp_f32 v253, v253
    v_rcp_f32 v254, v254
    v_rcp_f32 v255, v255
    v_pk_mul_f32 v[252:253], v[252:253], v[208:209]
    v_pk_mul_f32 v[254:255], v[254:255], v[210:211]
    v_cvt_pk_bf16_f32 v208, v252, v253
    v_cvt_pk_bf16_f32 v209, v254, v255
    v_pk_mul_f32 v[252:253], v[212:213], v[212:213]
    v_pk_mul_f32 v[254:255], v[214:215], v[214:215]
    v_pk_fma_f32 v[252:253], v[252:253], v[18:19], v[18:19] op_sel:[0,1,0] op_sel_hi:[1,1,0]
    v_pk_fma_f32 v[254:255], v[254:255], v[18:19], v[18:19] op_sel:[0,1,0] op_sel_hi:[1,1,0]
    v_pk_mul_f32 v[252:253], v[252:253], v[212:213]
    v_pk_mul_f32 v[254:255], v[254:255], v[214:215]
    v_exp_f32 v252, v252
    v_exp_f32 v253, v253
    v_exp_f32 v254, v254
    v_exp_f32 v255, v255
    v_pk_fma_f32 v[252:253], v[252:253], v[26:27], v[26:27] op_sel_hi:[1,0,0]
    v_pk_fma_f32 v[254:255], v[254:255], v[26:27], v[26:27] op_sel_hi:[1,0,0]
    v_rcp_f32 v252, v252
    v_rcp_f32 v253, v253
    v_rcp_f32 v254, v254
    v_rcp_f32 v255, v255
    v_pk_mul_f32 v[252:253], v[252:253], v[212:213]
    v_pk_mul_f32 v[254:255], v[254:255], v[214:215]
    v_cvt_pk_bf16_f32 v210, v252, v253
    v_cvt_pk_bf16_f32 v211, v254, v255
    v_pk_mul_f32 v[252:253], v[216:217], v[216:217]
    v_pk_mul_f32 v[254:255], v[218:219], v[218:219]
    v_pk_fma_f32 v[252:253], v[252:253], v[18:19], v[18:19] op_sel:[0,1,0] op_sel_hi:[1,1,0]
    v_pk_fma_f32 v[254:255], v[254:255], v[18:19], v[18:19] op_sel:[0,1,0] op_sel_hi:[1,1,0]
    v_pk_mul_f32 v[252:253], v[252:253], v[216:217]
    v_pk_mul_f32 v[254:255], v[254:255], v[218:219]
    buffer_load_dwordx4 v248, s[24:27], s3 offen offset:3072 lds
    v_exp_f32 v252, v252
    v_exp_f32 v253, v253
    v_exp_f32 v254, v254
    v_exp_f32 v255, v255
    v_pk_fma_f32 v[252:253], v[252:253], v[26:27], v[26:27] op_sel_hi:[1,0,0]
    v_pk_fma_f32 v[254:255], v[254:255], v[26:27], v[26:27] op_sel_hi:[1,0,0]
    v_rcp_f32 v252, v252
    v_rcp_f32 v253, v253
    v_rcp_f32 v254, v254
    v_rcp_f32 v255, v255
    v_pk_mul_f32 v[252:253], v[252:253], v[216:217]
    v_pk_mul_f32 v[254:255], v[254:255], v[218:219]
    v_cvt_pk_bf16_f32 v212, v252, v253
    v_cvt_pk_bf16_f32 v213, v254, v255
    v_pk_mul_f32 v[252:253], v[220:221], v[220:221]
    v_pk_mul_f32 v[254:255], v[222:223], v[222:223]
    v_pk_fma_f32 v[252:253], v[252:253], v[18:19], v[18:19] op_sel:[0,1,0] op_sel_hi:[1,1,0]
    v_pk_fma_f32 v[254:255], v[254:255], v[18:19], v[18:19] op_sel:[0,1,0] op_sel_hi:[1,1,0]
    v_pk_mul_f32 v[252:253], v[252:253], v[220:221]
    v_pk_mul_f32 v[254:255], v[254:255], v[222:223]
    v_exp_f32 v252, v252
    v_exp_f32 v253, v253
    v_exp_f32 v254, v254
    v_exp_f32 v255, v255
    v_pk_fma_f32 v[252:253], v[252:253], v[26:27], v[26:27] op_sel_hi:[1,0,0]
    v_pk_fma_f32 v[254:255], v[254:255], v[26:27], v[26:27] op_sel_hi:[1,0,0]
    v_rcp_f32 v252, v252
    v_rcp_f32 v253, v253
    v_rcp_f32 v254, v254
    v_rcp_f32 v255, v255
    v_pk_mul_f32 v[252:253], v[252:253], v[220:221]
    v_pk_mul_f32 v[254:255], v[254:255], v[222:223]
    v_cvt_pk_bf16_f32 v214, v252, v253
    v_cvt_pk_bf16_f32 v215, v254, v255
    buffer_store_dwordx4 v[208:211], v1, s[28:31], s58 offen offset:2048 sc1
    buffer_store_dwordx4 v[212:215], v1, s[28:31], s58 offen offset:3072 sc1
    s_add_u32 m0, s54, 8192
    s_add_u32 s3, s2, 409600
    buffer_load_dwordx4 v20, s[24:27], s3 offen lds
    buffer_load_dwordx4 v15, s[24:27], s3 offen offset:1024 lds
    buffer_load_dwordx4 v21, s[24:27], s3 offen offset:2048 lds
    buffer_load_dwordx4 v248, s[24:27], s3 offen offset:3072 lds
    s_add_u32 m0, s54, 12288
    s_add_u32 s3, s2, 442368
    buffer_load_dwordx4 v20, s[24:27], s3 offen lds
    buffer_load_dwordx4 v15, s[24:27], s3 offen offset:1024 lds
    s_waitcnt vmcnt(6)
    s_barrier
    s_cmp_lg_u32 s44, 0
    s_cbranch_scc1 L_w0_26
    s_add_u32 s54, s50, 11
    v_mov_b32 v18, s54
    v_mov_b32 v19, s51
    s_lshl_b32 s55, s45, 7
    s_lshl_b32 s56, s46, 3
    s_add_u32 s55, s55, s56
    s_add_u32 s55, s55, 0x1000
    v_mov_b32 v17, 0
    s_mov_b64 exec, 1
    s_cmp_eq_u32 s52, 1
    s_cbranch_scc1 L_fast_27
    buffer_store_dwordx2 v[18:19], v17, s[28:31], s55 offen sc1
    s_branch L_stdone_28
L_fast_27:
    buffer_store_dwordx2 v[18:19], v17, s[28:31], s55 offen
L_stdone_28:
    s_mov_b64 exec, -1
L_w0_26:
    s_branch L_p5
L_p4_skip:
    s_and_b32 s55, s45, 1
    s_lshl_b32 s55, s55, 1
    s_lshr_b32 s56, s46, 3
    s_add_u32 s55, s55, s56
    s_lshl_b32 s55, s55, 2
    s_add_u32 s55, s55, s44
    s_mul_i32 s55, s55, 114688
    s_lshr_b32 s56, s24, 7
    s_sub_u32 s56, 3, s56
    s_and_b32 s56, s56, 7
    s_lshl_b32 s56, s56, 7
    s_add_u32 s55, s55, s56
    v_lshlrev_b32 v17, 10, v0
    v_add_u32 v18, 49152, v17
    buffer_load_dword v32, v17, s[24:27], s55 offen
    buffer_load_dword v33, v18, s[24:27], s55 offen
    s_waitcnt vmcnt(0) lgkmcnt(0)
    v_accvgpr_read_b32 v20, a255
    v_add_u32 v15, 7168, v20
    v_add_u32 v21, 14336, v20
    v_add_u32 v248, 21504, v20
    s_add_u32 m0, s0, 131072
    s_add_u32 s3, s2, 0
    buffer_load_dwordx4 v20, s[24:27], s3 offen lds
    buffer_load_dwordx4 v15, s[24:27], s3 offen offset:1024 lds
    buffer_load_dwordx4 v21, s[24:27], s3 offen offset:2048 lds
    buffer_load_dwordx4 v248, s[24:27], s3 offen offset:3072 lds
    s_add_u32 m0, s0, 135168
    s_add_u32 s3, s2, 32768
    buffer_load_dwordx4 v20, s[24:27], s3 offen lds
    buffer_load_dwordx4 v15, s[24:27], s3 offen offset:1024 lds
    s_waitcnt vmcnt(0)
    ds_read_b64_tr_b16 a[0:1], v30 offset:0
    ds_read_b64_tr_b16 a[2:3], v30 offset:1024
    ds_read_b64_tr_b16 a[4:5], v31 offset:0
    ds_read_b64_tr_b16 a[6:7], v31 offset:1024
    ds_read_b64_tr_b16 a[8:9], v30 offset:2048
    ds_read_b64_tr_b16 a[10:11], v30 offset:3072
    ds_read_b64_tr_b16 a[12:13], v31 offset:2048
    ds_read_b64_tr_b16 a[14:15], v31 offset:3072
    ds_read_b64_tr_b16 a[16:17], v30 offset:4096
    ds_read_b64_tr_b16 a[18:19], v30 offset:5120
    ds_read_b64_tr_b16 a[20:21], v31 offset:4096
    ds_read_b64_tr_b16 a[22:23], v31 offset:5120
    s_waitcnt lgkmcnt(0)
    s_add_u32 m0, s0, 131072
    s_add_u32 s3, s2, 49152
    buffer_load_dwordx4 v20, s[24:27], s3 offen lds
    buffer_load_dwordx4 v15, s[24:27], s3 offen offset:1024 lds
    buffer_load_dwordx4 v21, s[24:27], s3 offen offset:2048 lds
    buffer_load_dwordx4 v248, s[24:27], s3 offen offset:3072 lds
    s_add_u32 m0, s0, 135168
    s_add_u32 s3, s2, 81920
    buffer_load_dwordx4 v20, s[24:27], s3 offen lds
    buffer_load_dwordx4 v15, s[24:27], s3 offen offset:1024 lds
    s_waitcnt vmcnt(0)
    ds_read_b64_tr_b16 a[24:25], v30 offset:0
    ds_read_b64_tr_b16 a[26:27], v30 offset:1024
    ds_read_b64_tr_b16 a[28:29], v31 offset:0
    ds_read_b64_tr_b16 a[30:31], v31 offset:1024
    ds_read_b64_tr_b16 a[32:33], v30 offset:2048
    ds_read_b64_tr_b16 a[34:35], v30 offset:3072
    ds_read_b64_tr_b16 a[36:37], v31 offset:2048
    ds_read_b64_tr_b16 a[38:39], v31 offset:3072
    ds_read_b64_tr_b16 a[40:41], v30 offset:4096
    ds_read_b64_tr_b16 a[42:43], v30 offset:5120
    ds_read_b64_tr_b16 a[44:45], v31 offset:4096
    ds_read_b64_tr_b16 a[46:47], v31 offset:5120
    s_waitcnt lgkmcnt(0)
    s_add_u32 m0, s0, 131072
    s_add_u32 s3, s2, 98304
    buffer_load_dwordx4 v20, s[24:27], s3 offen lds
    buffer_load_dwordx4 v15, s[24:27], s3 offen offset:1024 lds
    buffer_load_dwordx4 v21, s[24:27], s3 offen offset:2048 lds
    buffer_load_dwordx4 v248, s[24:27], s3 offen offset:3072 lds
    s_add_u32 m0, s0, 135168
    s_add_u32 s3, s2, 131072
    buffer_load_dwordx4 v20, s[24:27], s3 offen lds
    buffer_load_dwordx4 v15, s[24:27], s3 offen offset:1024 lds
    s_waitcnt vmcnt(0)
    ds_read_b64_tr_b16 a[48:49], v30 offset:0
    ds_read_b64_tr_b16 a[50:51], v30 offset:1024
    ds_read_b64_tr_b16 a[52:53], v31 offset:0
    ds_read_b64_tr_b16 a[54:55], v31 offset:1024
    ds_read_b64_tr_b16 a[56:57], v30 offset:2048
    ds_read_b64_tr_b16 a[58:59], v30 offset:3072
    ds_read_b64_tr_b16 a[60:61], v31 offset:2048
    ds_read_b64_tr_b16 a[62:63], v31 offset:3072
    ds_read_b64_tr_b16 a[64:65], v30 offset:4096
    ds_read_b64_tr_b16 a[66:67], v30 offset:5120
    ds_read_b64_tr_b16 a[68:69], v31 offset:4096
    ds_read_b64_tr_b16 a[70:71], v31 offset:5120
    s_waitcnt lgkmcnt(0)
    s_add_u32 m0, s0, 131072
    s_add_u32 s3, s2, 147456
    buffer_load_dwordx4 v20, s[24:27], s3 offen lds
    buffer_load_dwordx4 v15, s[24:27], s3 offen offset:1024 lds
    buffer_load_dwordx4 v21, s[24:27], s3 offen offset:2048 lds
    buffer_load_dwordx4 v248, s[24:27], s3 offen offset:3072 lds
    s_add_u32 m0, s0, 135168
    s_add_u32 s3, s2, 180224
    buffer_load_dwordx4 v20, s[24:27], s3 offen lds
    buffer_load_dwordx4 v15, s[24:27], s3 offen offset:1024 lds
    s_waitcnt vmcnt(0)
    ds_read_b64_tr_b16 a[72:73], v30 offset:0
    ds_read_b64_tr_b16 a[74:75], v30 offset:1024
    ds_read_b64_tr_b16 a[76:77], v31 offset:0
    ds_read_b64_tr_b16 a[78:79], v31 offset:1024
    ds_read_b64_tr_b16 a[80:81], v30 offset:2048
    ds_read_b64_tr_b16 a[82:83], v30 offset:3072
    ds_read_b64_tr_b16 a[84:85], v31 offset:2048
    ds_read_b64_tr_b16 a[86:87], v31 offset:3072
    ds_read_b64_tr_b16 a[88:89], v30 offset:4096
    ds_read_b64_tr_b16 a[90:91], v30 offset:5120
    ds_read_b64_tr_b16 a[92:93], v31 offset:4096
    ds_read_b64_tr_b16 a[94:95], v31 offset:5120
    s_waitcnt lgkmcnt(0)
    s_add_u32 m0, s0, 131072
    s_add_u32 s3, s2, 196608
    buffer_load_dwordx4 v20, s[24:27], s3 offen lds
    buffer_load_dwordx4 v15, s[24:27], s3 offen offset:1024 lds
    buffer_load_dwordx4 v21, s[24:27], s3 offen offset:2048 lds
    buffer_load_dwordx4 v248, s[24:27], s3 offen offset:3072 lds
    s_add_u32 m0, s0, 135168
    s_add_u32 s3, s2, 229376
    buffer_load_dwordx4 v20, s[24:27], s3 offen lds
    buffer_load_dwordx4 v15, s[24:27], s3 offen offset:1024 lds
    s_waitcnt vmcnt(0)
    ds_read_b64_tr_b16 a[96:97], v30 offset:0
    ds_read_b64_tr_b16 a[98:99], v30 offset:1024
    ds_read_b64_tr_b16 a[100:101], v31 offset:0
    ds_read_b64_tr_b16 a[102:103], v31 offset:1024
    ds_read_b64_tr_b16 a[104:105], v30 offset:2048
    ds_read_b64_tr_b16 a[106:107], v30 offset:3072
    ds_read_b64_tr_b16 a[108:109], v31 offset:2048
    ds_read_b64_tr_b16 a[110:111], v31 offset:3072
    ds_read_b64_tr_b16 a[112:113], v30 offset:4096
    ds_read_b64_tr_b16 a[114:115], v30 offset:5120
    ds_read_b64_tr_b16 a[116:117], v31 offset:4096
    ds_read_b64_tr_b16 a[118:119], v31 offset:5120
    s_waitcnt lgkmcnt(0)
    s_add_u32 m0, s0, 131072
    s_add_u32 s3, s2, 245760
    buffer_load_dwordx4 v20, s[24:27], s3 offen lds
    buffer_load_dwordx4 v15, s[24:27], s3 offen offset:1024 lds
    buffer_load_dwordx4 v21, s[24:27], s3 offen offset:2048 lds
    buffer_load_dwordx4 v248, s[24:27], s3 offen offset:3072 lds
    s_add_u32 m0, s0, 135168
    s_add_u32 s3, s2, 278528
    buffer_load_dwordx4 v20, s[24:27], s3 offen lds
    buffer_load_dwordx4 v15, s[24:27], s3 offen offset:1024 lds
    s_waitcnt vmcnt(0)
    ds_read_b64_tr_b16 a[120:121], v30 offset:0
    ds_read_b64_tr_b16 a[122:123], v30 offset:1024
    ds_read_b64_tr_b16 a[124:125], v31 offset:0
    ds_read_b64_tr_b16 a[126:127], v31 offset:1024
    ds_read_b64_tr_b16 a[128:129], v30 offset:2048
    ds_read_b64_tr_b16 a[130:131], v30 offset:3072
    ds_read_b64_tr_b16 a[132:133], v31 offset:2048
    ds_read_b64_tr_b16 a[134:135], v31 offset:3072
    ds_read_b64_tr_b16 a[136:137], v30 offset:4096
    ds_read_b64_tr_b16 a[138:139], v30 offset:5120
    ds_read_b64_tr_b16 a[140:141], v31 offset:4096
    ds_read_b64_tr_b16 a[142:143], v31 offset:5120
    s_waitcnt lgkmcnt(0)
    s_add_u32 m0, s0, 131072
    s_add_u32 s3, s2, 294912
    buffer_load_dwordx4 v20, s[24:27], s3 offen lds
    buffer_load_dwordx4 v15, s[24:27], s3 offen offset:1024 lds
    buffer_load_dwordx4 v21, s[24:27], s3 offen offset:2048 lds
    buffer_load_dwordx4 v248, s[24:27], s3 offen offset:3072 lds
    s_add_u32 m0, s0, 135168
    s_add_u32 s3, s2, 327680
    buffer_load_dwordx4 v20, s[24:27], s3 offen lds
    buffer_load_dwordx4 v15, s[24:27], s3 offen offset:1024 lds
    s_lshl_b32 s54, s44, 14
    s_add_u32 m0, s54, 0
    s_add_u32 s3, s2, 344064
    buffer_load_dwordx4 v20, s[24:27], s3 offen lds
    buffer_load_dwordx4 v15, s[24:27], s3 offen offset:1024 lds
    buffer_load_dwordx4 v21, s[24:27], s3 offen offset:2048 lds
    buffer_load_dwordx4 v248, s[24:27], s3 offen offset:3072 lds
    s_add_u32 m0, s54, 4096
    s_add_u32 s3, s2, 376832
    buffer_load_dwordx4 v20, s[24:27], s3 offen lds
    buffer_load_dwordx4 v15, s[24:27], s3 offen offset:1024 lds
    buffer_load_dwordx4 v21, s[24:27], s3 offen offset:2048 lds
    buffer_load_dwordx4 v248, s[24:27], s3 offen offset:3072 lds
    s_add_u32 m0, s54, 8192
    s_add_u32 s3, s2, 409600
    buffer_load_dwordx4 v20, s[24:27], s3 offen lds
    buffer_load_dwordx4 v15, s[24:27], s3 offen offset:1024 lds
    buffer_load_dwordx4 v21, s[24:27], s3 offen offset:2048 lds
    buffer_load_dwordx4 v248, s[24:27], s3 offen offset:3072 lds
    s_add_u32 m0, s54, 12288
    s_add_u32 s3, s2, 442368
    buffer_load_dwordx4 v20, s[24:27], s3 offen lds
    buffer_load_dwordx4 v15, s[24:27], s3 offen offset:1024 lds
L_p5:
    s_waitcnt vmcnt(0)
    s_lshl_b32 s58, s44, 14
    ds_read_b64_tr_b16 a[144:145], v30 offset:0
    ds_read_b64_tr_b16 a[146:147], v30 offset:1024
    ds_read_b64_tr_b16 a[148:149], v31 offset:0
    ds_read_b64_tr_b16 a[150:151], v31 offset:1024
    ds_read_b64_tr_b16 a[152:153], v30 offset:2048
    ds_read_b64_tr_b16 a[154:155], v30 offset:3072
    ds_read_b64_tr_b16 a[156:157], v31 offset:2048
    ds_read_b64_tr_b16 a[158:159], v31 offset:3072
    ds_read_b64_tr_b16 a[160:161], v30 offset:4096
    ds_read_b64_tr_b16 a[162:163], v30 offset:5120
    ds_read_b64_tr_b16 a[164:165], v31 offset:4096
    ds_read_b64_tr_b16 a[166:167], v31 offset:5120
    v_bfe_u32 v19, v0, 2, 2
    v_lshlrev_b32 v26, 7, v19
    v_lshrrev_b32 v19, 1, v19
    v_lshl_add_u32 v26, v19, 6, v26
    v_bfe_u32 v19, v0, 4, 1
    v_lshl_add_u32 v26, v19, 5, v26
    v_and_b32 v19, 3, v0
    v_lshl_add_u32 v26, v19, 3, v26
    v_lshrrev_b32 v19, 5, v0
    v_lshl_add_u32 v26, v19, 9, v26
    s_lshl_b32 s55, s61, 6
    s_lshl_b32 s56, s62, 5
    s_or_b32 s55, s55, s56
    v_xor_b32 v26, s55, v26
    s_add_u32 s55, s58, 0
    v_add_u32 v26, s55, v26
    v_xor_b32 v27, 64, v26
    ds_read_b64_tr_b16 a[168:169], v26 offset:0
    ds_read_b64_tr_b16 a[170:171], v26 offset:1024
    ds_read_b64_tr_b16 a[172:173], v27 offset:0
    ds_read_b64_tr_b16 a[174:175], v27 offset:1024
    ds_read_b64_tr_b16 a[176:177], v26 offset:2048
    ds_read_b64_tr_b16 a[178:179], v26 offset:3072
    ds_read_b64_tr_b16 a[180:181], v27 offset:2048
    ds_read_b64_tr_b16 a[182:183], v27 offset:3072
    ds_read_b64_tr_b16 a[184:185], v26 offset:4096
    ds_read_b64_tr_b16 a[186:187], v26 offset:5120
    ds_read_b64_tr_b16 a[188:189], v27 offset:4096
    ds_read_b64_tr_b16 a[190:191], v27 offset:5120
    ds_read_b64_tr_b16 a[192:193], v26 offset:6144
    ds_read_b64_tr_b16 a[194:195], v26 offset:7168
    ds_read_b64_tr_b16 a[196:197], v27 offset:6144
    ds_read_b64_tr_b16 a[198:199], v27 offset:7168
    ds_read_b64_tr_b16 a[200:201], v26 offset:8192
    ds_read_b64_tr_b16 a[202:203], v26 offset:9216
    ds_read_b64_tr_b16 a[204:205], v27 offset:8192
    ds_read_b64_tr_b16 a[206:207], v27 offset:9216
    ds_read_b64_tr_b16 a[208:209], v26 offset:10240
    ds_read_b64_tr_b16 a[210:211], v26 offset:11264
    ds_read_b64_tr_b16 a[212:213], v27 offset:10240
    ds_read_b64_tr_b16 a[214:215], v27 offset:11264
    ds_read_b64_tr_b16 a[216:217], v26 offset:12288
    ds_read_b64_tr_b16 a[218:219], v26 offset:13312
    ds_read_b64_tr_b16 a[220:221], v27 offset:12288
    ds_read_b64_tr_b16 a[222:223], v27 offset:13312
    s_mul_i32 s4, s47, 224
    s_mul_i32 s5, s44, 28
    s_add_u32 s4, s4, s5
    s_lshl_b32 s4, s4, 10
    s_add_u32 s4, s4, 0x810000
    s_cmp_lg_u32 s44, 0
    s_cbranch_scc1 L_w0_29
    s_mov_b32 s56, 63479
    s_mov_b32 s57, 0
    v_and_b32 v17, 15, v0
    v_lshlrev_b32 v17, 3, v17
    s_lshl_b32 s55, s45, 7
    s_add_u32 s55, s55, 0x1000
    s_add_u32 s54, s50, 11
    s_mov_b32 s59, 0x40000
    s_waitcnt vmcnt(0) lgkmcnt(0)
    s_nop 7
L_poll_30:
    buffer_load_dwordx2 v[18:19], v17, s[28:31], s55 offen sc1
    s_waitcnt vmcnt(0)
    v_subrev_u32 v18, s54, v18
    v_cmp_eq_u32 vcc, s51, v19
    v_cmp_gt_u32 s[100:101], 1, v18
    s_and_b64 vcc, vcc, s[100:101]
    s_andn2_b64 s[100:101], s[56:57], vcc
    s_cbranch_scc0 L_polldone_31
    s_sub_u32 s59, s59, 1
    s_cbranch_scc1 L_pollto_32
    s_branch L_poll_30
L_pollto_32:
    v_mov_b32 v18, 259
    v_mov_b32 v19, 0
    global_store_dword v19, v18, s[6:7]
    s_waitcnt vmcnt(0)
L_polldone_31:
L_w0_29:
    s_barrier
    s_add_u32 s5, s4, 0
    buffer_load_dwordx4 v[32:35], v1, s[28:31], s5 offen offset:0 sc1
    buffer_load_dwordx4 v[36:39], v1, s[28:31], s5 offen offset:1024 sc1
    buffer_load_dwordx4 v[40:43], v1, s[28:31], s5 offen offset:2048 sc1
    buffer_load_dwordx4 v[44:47], v1, s[28:31], s5 offen offset:3072 sc1
    s_add_u32 s5, s4, 4096
    buffer_load_dwordx4 v[48:51], v1, s[28:31], s5 offen offset:0 sc1
    buffer_load_dwordx4 v[52:55], v1, s[28:31], s5 offen offset:1024 sc1
    buffer_load_dwordx4 v[56:59], v1, s[28:31], s5 offen offset:2048 sc1
    buffer_load_dwordx4 v[60:63], v1, s[28:31], s5 offen offset:3072 sc1
    s_add_u32 s5, s4, 8192
    buffer_load_dwordx4 v[64:67], v1, s[28:31], s5 offen offset:0 sc1
    buffer_load_dwordx4 v[68:71], v1, s[28:31], s5 offen offset:1024 sc1
    v_lshlrev_b32 v168, 16, v10
    v_and_b32 v169, 0xffff0000, v10
    v_lshlrev_b32 v170, 16, v11
    v_and_b32 v171, 0xffff0000, v11
    v_lshlrev_b32 v172, 16, v12
    v_and_b32 v173, 0xffff0000, v12
    v_lshlrev_b32 v174, 16, v13
    v_and_b32 v175, 0xffff0000, v13
    v_lshlrev_b32 v192, 16, v2
    v_and_b32 v193, 0xffff0000, v2
    v_lshlrev_b32 v194, 16, v3
    v_and_b32 v195, 0xffff0000, v3
    v_lshlrev_b32 v196, 16, v4
    v_and_b32 v197, 0xffff0000, v4
    v_lshlrev_b32 v198, 16, v5
    v_and_b32 v199, 0xffff0000, v5
    v_pk_add_f32 v[192:193], v[192:193], v[168:169]
    v_pk_mov_b32 v[200:201], 0, 0
    v_pk_add_f32 v[194:195], v[194:195], v[170:171]
    v_pk_mov_b32 v[202:203], 0, 0
    v_pk_add_f32 v[196:197], v[196:197], v[172:173]
    v_pk_mov_b32 v[204:205], 0, 0
    v_pk_add_f32 v[198:199], v[198:199], v[174:175]
    v_pk_mov_b32 v[206:207], 0, 0
    v_lshlrev_b32 v224, 16, v6
    v_and_b32 v225, 0xffff0000, v6
    v_lshlrev_b32 v226, 16, v7
    v_and_b32 v227, 0xffff0000, v7
    v_lshlrev_b32 v228, 16, v8
    v_and_b32 v229, 0xffff0000, v8
    v_lshlrev_b32 v230, 16, v9
    v_and_b32 v231, 0xffff0000, v9
    v_pk_add_f32 v[224:225], v[224:225], v[168:169]
    v_pk_mov_b32 v[232:233], 0, 0
    v_pk_add_f32 v[226:227], v[226:227], v[170:171]
    v_pk_mov_b32 v[234:235], 0, 0
    v_pk_add_f32 v[228:229], v[228:229], v[172:173]
    v_pk_mov_b32 v[236:237], 0, 0
    v_pk_add_f32 v[230:231], v[230:231], v[174:175]
    v_pk_mov_b32 v[238:239], 0, 0
    s_waitcnt vmcnt(9)
    v_mfma_f32_32x32x16_bf16 v[192:207], a[0:3], v[32:35], v[192:207]
    buffer_load_dwordx4 v[72:75], v1, s[28:31], s5 offen offset:2048 sc1
    v_and_b32 v17, 31, v0
    v_mul_u32_u24 v17, 272, v17
    v_mfma_f32_32x32x16_bf16 v[208:223], a[4:7], v[32:35], 0
    v_lshrrev_b32 v18, 5, v0
    v_lshl_add_u32 v17, v18, 4, v17
    s_waitcnt vmcnt(9)
    v_mfma_f32_32x32x16_bf16 v[192:207], a[8:11], v[36:39], v[192:207]
    buffer_load_dwordx4 v[76:79], v1, s[28:31], s5 offen offset:3072 sc1
    s_mul_i32 s55, s44, 8704
    s_add_u32 s55, s55, 65536
    v_mfma_f32_32x32x16_bf16 v[208:223], a[12:15], v[36:39], v[208:223]
    s_xor_b32 s56, s44, 0
    s_lshl_b32 s56, s56, 6
    s_add_u32 s56, s56, s55
    s_waitcnt vmcnt(9)
    v_mfma_f32_32x32x16_bf16 v[192:207], a[16:19], v[40:43], v[192:207]
    s_add_u32 s5, s4, 12288
    buffer_load_dwordx4 v[80:83], v1, s[28:31], s5 offen offset:0 sc1
    v_add_u32 v22, s56, v17
    s_xor_b32 s56, s44, 1
    v_mfma_f32_32x32x16_bf16 v[208:223], a[20:23], v[40:43], v[208:223]
    s_lshl_b32 s56, s56, 6
    s_add_u32 s56, s56, s55
    s_waitcnt vmcnt(9)
    v_mfma_f32_32x32x16_bf16 v[192:207], a[24:27], v[44:47], v[192:207]
    buffer_load_dwordx4 v[84:87], v1, s[28:31], s5 offen offset:1024 sc1
    v_add_u32 v23, s56, v17
    s_xor_b32 s56, s44, 2
    s_lshl_b32 s56, s56, 6
    v_mfma_f32_32x32x16_bf16 v[208:223], a[28:31], v[44:47], v[208:223]
    s_add_u32 s56, s56, s55
    v_add_u32 v24, s56, v17
    s_waitcnt vmcnt(9)
    v_mfma_f32_32x32x16_bf16 v[192:207], a[32:35], v[48:51], v[192:207]
    buffer_load_dwordx4 v[88:91], v1, s[28:31], s5 offen offset:2048 sc1
    s_xor_b32 s56, s44, 3
    s_lshl_b32 s56, s56, 6
    v_mfma_f32_32x32x16_bf16 v[208:223], a[36:39], v[48:51], v[208:223]
    s_add_u32 s56, s56, s55
    v_add_u32 v25, s56, v17
    v_lshrrev_b32 v18, 3, v0
    s_waitcnt vmcnt(9)
    v_mfma_f32_32x32x16_bf16 v[192:207], a[40:43], v[52:55], v[192:207]
    buffer_load_dwordx4 v[92:95], v1, s[28:31], s5 offen offset:3072 sc1
    v_and_b32 v19, 7, v0
    v_lshlrev_b32 v19, 4, v19
    v_mfma_f32_32x32x16_bf16 v[208:223], a[44:47], v[52:55], v[208:223]
    v_lshl_add_u32 v20, v18, 10, v19
    v_mul_u32_u24 v18, 272, v18
    s_waitcnt vmcnt(9)
    v_mfma_f32_32x32x16_bf16 v[192:207], a[48:51], v[56:59], v[192:207]
    s_add_u32 s5, s4, 16384
    buffer_load_dwordx4 v[96:99], v1, s[28:31], s5 offen offset:0 sc1
    v_lshl_add_u32 v18, v19, 1, v18
    s_mul_i32 s55, s44, 2176
    s_add_u32 s55, s55, 65536
    v_mfma_f32_32x32x16_bf16 v[208:223], a[52:55], v[56:59], v[208:223]
    v_add_u32 v26, s55, v18
    s_lshl_b32 s54, s47, 16
    s_waitcnt vmcnt(9)
    v_mfma_f32_32x32x16_bf16 v[192:207], a[56:59], v[60:63], v[192:207]
    buffer_load_dwordx4 v[100:103], v1, s[28:31], s5 offen offset:1024 sc1
    s_lshl_b32 s55, s44, 13
    s_add_u32 s54, s54, s55
    v_mfma_f32_32x32x16_bf16 v[208:223], a[60:63], v[60:63], v[208:223]
    s_lshl_b32 s55, s48, 7
    s_add_u32 s54, s54, s55
    s_add_u32 s55, s54, 32768
    s_waitcnt vmcnt(9)
    v_mfma_f32_32x32x16_bf16 v[192:207], a[64:67], v[64:67], v[192:207]
    buffer_load_dwordx4 v[104:107], v1, s[28:31], s5 offen offset:2048 sc1
    v_mfma_f32_32x32x16_bf16 v[208:223], a[68:71], v[64:67], v[208:223]
    s_waitcnt vmcnt(9)
    v_mfma_f32_32x32x16_bf16 v[192:207], a[72:75], v[68:71], v[192:207]
    buffer_load_dwordx4 v[108:111], v1, s[28:31], s5 offen offset:3072 sc1
    v_mfma_f32_32x32x16_bf16 v[208:223], a[76:79], v[68:71], v[208:223]
    s_waitcnt vmcnt(9)
    v_mfma_f32_32x32x16_bf16 v[192:207], a[80:83], v[72:75], v[192:207]
    s_add_u32 s5, s4, 20480
    buffer_load_dwordx4 v[112:115], v1, s[28:31], s5 offen offset:0 sc1
    v_mfma_f32_32x32x16_bf16 v[208:223], a[84:87], v[72:75], v[208:223]
    s_waitcnt vmcnt(9)
    v_mfma_f32_32x32x16_bf16 v[192:207], a[88:91], v[76:79], v[192:207]
    buffer_load_dwordx4 v[116:119], v1, s[28:31], s5 offen offset:1024 sc1
    v_mfma_f32_32x32x16_bf16 v[208:223], a[92:95], v[76:79], v[208:223]
    s_waitcnt vmcnt(9)
    v_mfma_f32_32x32x16_bf16 v[192:207], a[96:99], v[80:83], v[192:207]
    buffer_load_dwordx4 v[120:123], v1, s[28:31], s5 offen offset:2048 sc1
    v_mfma_f32_32x32x16_bf16 v[208:223], a[100:103], v[80:83], v[208:223]
    s_waitcnt vmcnt(9)
    v_mfma_f32_32x32x16_bf16 v[192:207], a[104:107], v[84:87], v[192:207]
    buffer_load_dwordx4 v[124:127], v1, s[28:31], s5 offen offset:3072 sc1
    v_mfma_f32_32x32x16_bf16 v[208:223], a[108:111], v[84:87], v[208:223]
    s_waitcnt vmcnt(9)
    v_mfma_f32_32x32x16_bf16 v[192:207], a[112:115], v[88:91], v[192:207]
    s_add_u32 s5, s4, 24576
    buffer_load_dwordx4 v[128:131], v1, s[28:31], s5 offen offset:0 sc1
    v_mfma_f32_32x32x16_bf16 v[208:223], a[116:119], v[88:91], v[208:223]
    s_waitcnt vmcnt(9)
    v_mfma_f32_32x32x16_bf16 v[192:207], a[120:123], v[92:95], v[192:207]
    buffer_load_dwordx4 v[132:135], v1, s[28:31], s5 offen offset:1024 sc1
    v_mfma_f32_32x32x16_bf16 v[208:223], a[124:127], v[92:95], v[208:223]
    s_waitcnt vmcnt(9)
    v_mfma_f32_32x32x16_bf16 v[192:207], a[128:131], v[96:99], v[192:207]
    buffer_load_dwordx4 v[136:139], v1, s[28:31], s5 offen offset:2048 sc1
    v_mfma_f32_32x32x16_bf16 v[208:223], a[132:135], v[96:99], v[208:223]
    s_waitcnt vmcnt(9)
    v_mfma_f32_32x32x16_bf16 v[192:207], a[136:139], v[100:103], v[192:207]
    buffer_load_dwordx4 v[140:143], v1, s[28:31], s5 offen offset:3072 sc1
    v_mfma_f32_32x32x16_bf16 v[208:223], a[140:143], v[100:103], v[208:223]
    s_waitcnt vmcnt(9) lgkmcnt(15)
    v_mfma_f32_32x32x16_bf16 v[192:207], a[144:147], v[104:107], v[192:207]
    s_add_u32 s5, s4, 114688
    buffer_load_dwordx4 v[144:147], v1, s[28:31], s5 offen offset:0 sc1
    v_mfma_f32_32x32x16_bf16 v[208:223], a[148:151], v[104:107], v[208:223]
    s_waitcnt vmcnt(9)
    v_mfma_f32_32x32x16_bf16 v[192:207], a[152:155], v[108:111], v[192:207]
    buffer_load_dwordx4 v[148:151], v1, s[28:31], s5 offen offset:1024 sc1
    v_mfma_f32_32x32x16_bf16 v[208:223], a[156:159], v[108:111], v[208:223]
    s_waitcnt vmcnt(9)
    v_mfma_f32_32x32x16_bf16 v[192:207], a[160:163], v[112:115], v[192:207]
    buffer_load_dwordx4 v[152:155], v1, s[28:31], s5 offen offset:2048 sc1
    v_mfma_f32_32x32x16_bf16 v[208:223], a[164:167], v[112:115], v[208:223]
    s_waitcnt vmcnt(9)
    v_mfma_f32_32x32x16_bf16 v[192:207], a[168:171], v[116:119], v[192:207]
    buffer_load_dwordx4 v[156:159], v1, s[28:31], s5 offen offset:3072 sc1
    v_mfma_f32_32x32x16_bf16 v[208:223], a[172:175], v[116:119], v[208:223]
    s_waitcnt vmcnt(9)
    v_mfma_f32_32x32x16_bf16 v[192:207], a[176:179], v[120:123], v[192:207]
    s_add_u32 s5, s4, 118784
    buffer_load_dwordx4 v[160:163], v1, s[28:31], s5 offen offset:0 sc1
    v_mfma_f32_32x32x16_bf16 v[208:223], a[180:183], v[120:123], v[208:223]
    s_waitcnt vmcnt(9)
    v_mfma_f32_32x32x16_bf16 v[192:207], a[184:187], v[124:127], v[192:207]
    buffer_load_dwordx4 v[164:167], v1, s[28:31], s5 offen offset:1024 sc1
    v_mfma_f32_32x32x16_bf16 v[208:223], a[188:191], v[124:127], v[208:223]
    s_waitcnt vmcnt(9) lgkmcnt(14)
    v_mfma_f32_32x32x16_bf16 v[192:207], a[192:195], v[128:131], v[192:207]
    buffer_load_dwordx4 v[32:35], v1, s[28:31], s5 offen offset:2048 sc1
    s_waitcnt lgkmcnt(12)
    v_mfma_f32_32x32x16_bf16 v[208:223], a[196:199], v[128:131], v[208:223]
    s_waitcnt vmcnt(9) lgkmcnt(10)
    v_mfma_f32_32x32x16_bf16 v[192:207], a[200:203], v[132:135], v[192:207]
    buffer_load_dwordx4 v[36:39], v1, s[28:31], s5 offen offset:3072 sc1
    s_waitcnt lgkmcnt(8)
    v_mfma_f32_32x32x16_bf16 v[208:223], a[204:207], v[132:135], v[208:223]
    s_waitcnt vmcnt(9) lgkmcnt(6)
    v_mfma_f32_32x32x16_bf16 v[192:207], a[208:211], v[136:139], v[192:207]
    s_add_u32 s5, s4, 122880
    buffer_load_dwordx4 v[40:43], v1, s[28:31], s5 offen offset:0 sc1
    s_waitcnt lgkmcnt(4)
    v_mfma_f32_32x32x16_bf16 v[208:223], a[212:215], v[136:139], v[208:223]
    s_waitcnt vmcnt(9) lgkmcnt(2)
    v_mfma_f32_32x32x16_bf16 v[192:207], a[216:219], v[140:143], v[192:207]
    buffer_load_dwordx4 v[44:47], v1, s[28:31], s5 offen offset:1024 sc1
    s_waitcnt lgkmcnt(0)
    v_mfma_f32_32x32x16_bf16 v[208:223], a[220:223], v[140:143], v[208:223]
    s_waitcnt vmcnt(9)
    v_mfma_f32_32x32x16_bf16 v[224:239], a[0:3], v[144:147], v[224:239]
    buffer_load_dwordx4 v[48:51], v1, s[28:31], s5 offen offset:2048 sc1
    v_mfma_f32_32x32x16_bf16 v[240:255], a[4:7], v[144:147], 0
    s_waitcnt vmcnt(9)
    v_mfma_f32_32x32x16_bf16 v[224:239], a[8:11], v[148:151], v[224:239]
    buffer_load_dwordx4 v[52:55], v1, s[28:31], s5 offen offset:3072 sc1
    v_mfma_f32_32x32x16_bf16 v[240:255], a[12:15], v[148:151], v[240:255]
    s_waitcnt vmcnt(9)
    v_mfma_f32_32x32x16_bf16 v[224:239], a[16:19], v[152:155], v[224:239]
    s_add_u32 s5, s4, 126976
    buffer_load_dwordx4 v[56:59], v1, s[28:31], s5 offen offset:0 sc1
    ds_write_b128 v22, v[192:195] offset:0
    v_mfma_f32_32x32x16_bf16 v[240:255], a[20:23], v[152:155], v[240:255]
    ds_write_b128 v22, v[196:199] offset:32
    s_waitcnt vmcnt(9)
    v_mfma_f32_32x32x16_bf16 v[224:239], a[24:27], v[156:159], v[224:239]
    buffer_load_dwordx4 v[60:63], v1, s[28:31], s5 offen offset:1024 sc1
    ds_write_b128 v23, v[200:203] offset:0
    v_mfma_f32_32x32x16_bf16 v[240:255], a[28:31], v[156:159], v[240:255]
    ds_write_b128 v23, v[204:207] offset:32
    s_waitcnt vmcnt(9)
    v_mfma_f32_32x32x16_bf16 v[224:239], a[32:35], v[160:163], v[224:239]
    buffer_load_dwordx4 v[64:67], v1, s[28:31], s5 offen offset:2048 sc1
    ds_write_b128 v24, v[208:211] offset:0
    v_mfma_f32_32x32x16_bf16 v[240:255], a[36:39], v[160:163], v[240:255]
    ds_write_b128 v24, v[212:215] offset:32
    s_waitcnt vmcnt(9)
    v_mfma_f32_32x32x16_bf16 v[224:239], a[40:43], v[164:167], v[224:239]
    buffer_load_dwordx4 v[68:71], v1, s[28:31], s5 offen offset:3072 sc1
    ds_write_b128 v25, v[216:219] offset:0
    v_mfma_f32_32x32x16_bf16 v[240:255], a[44:47], v[164:167], v[240:255]
    ds_write_b128 v25, v[220:223] offset:32
    s_waitcnt vmcnt(9)
    v_mfma_f32_32x32x16_bf16 v[224:239], a[48:51], v[32:35], v[224:239]
    s_add_u32 s5, s4, 131072
    buffer_load_dwordx4 v[72:75], v1, s[28:31], s5 offen offset:0 sc1
    v_mfma_f32_32x32x16_bf16 v[240:255], a[52:55], v[32:35], v[240:255]
    s_waitcnt vmcnt(9)
    v_mfma_f32_32x32x16_bf16 v[224:239], a[56:59], v[36:39], v[224:239]
    buffer_load_dwordx4 v[76:79], v1, s[28:31], s5 offen offset:1024 sc1
    v_mfma_f32_32x32x16_bf16 v[240:255], a[60:63], v[36:39], v[240:255]
    s_waitcnt vmcnt(9)
    v_mfma_f32_32x32x16_bf16 v[224:239], a[64:67], v[40:43], v[224:239]
    buffer_load_dwordx4 v[80:83], v1, s[28:31], s5 offen offset:2048 sc1
    v_mfma_f32_32x32x16_bf16 v[240:255], a[68:71], v[40:43], v[240:255]
    s_waitcnt vmcnt(9)
    v_mfma_f32_32x32x16_bf16 v[224:239], a[72:75], v[44:47], v[224:239]
    buffer_load_dwordx4 v[84:87], v1, s[28:31], s5 offen offset:3072 sc1
    v_mfma_f32_32x32x16_bf16 v[240:255], a[76:79], v[44:47], v[240:255]
    s_waitcnt lgkmcnt(0)
    s_barrier
    ds_read_b128 v[192:195], v26 offset:0
    ds_read_b128 v[196:199], v26 offset:16
    ds_read_b128 v[200:203], v26 offset:8704
    ds_read_b128 v[204:207], v26 offset:8720
    ds_read_b128 v[208:211], v26 offset:17408
    ds_read_b128 v[212:215], v26 offset:17424
    ds_read_b128 v[216:219], v26 offset:26112
    ds_read_b128 v[220:223], v26 offset:26128
    s_waitcnt vmcnt(9)
    v_mfma_f32_32x32x16_bf16 v[224:239], a[80:83], v[48:51], v[224:239]
    s_add_u32 s5, s4, 135168
    buffer_load_dwordx4 v[88:91], v1, s[28:31], s5 offen offset:0 sc1
    v_mfma_f32_32x32x16_bf16 v[240:255], a[84:87], v[48:51], v[240:255]
    s_waitcnt vmcnt(9)
    v_mfma_f32_32x32x16_bf16 v[224:239], a[88:91], v[52:55], v[224:239]
    buffer_load_dwordx4 v[92:95], v1, s[28:31], s5 offen offset:1024 sc1
    v_mfma_f32_32x32x16_bf16 v[240:255], a[92:95], v[52:55], v[240:255]
    s_waitcnt vmcnt(9)
    v_mfma_f32_32x32x16_bf16 v[224:239], a[96:99], v[56:59], v[224:239]
    buffer_load_dwordx4 v[96:99], v1, s[28:31], s5 offen offset:2048 sc1
    s_waitcnt lgkmcnt(5)
    v_add_f32 v192, v192, v200
    v_mfma_f32_32x32x16_bf16 v[240:255], a[100:103], v[56:59], v[240:255]
    v_add_f32 v193, v193, v201
    s_waitcnt vmcnt(9)
    v_mfma_f32_32x32x16_bf16 v[224:239], a[104:107], v[60:63], v[224:239]
    buffer_load_dwordx4 v[100:103], v1, s[28:31], s5 offen offset:3072 sc1
    v_add_f32 v194, v194, v202
    v_add_f32 v195, v195, v203
    v_mfma_f32_32x32x16_bf16 v[240:255], a[108:111], v[60:63], v[240:255]
    s_waitcnt lgkmcnt(4)
    v_add_f32 v196, v196, v204
    s_waitcnt vmcnt(9)
    v_mfma_f32_32x32x16_bf16 v[224:239], a[112:115], v[64:67], v[224:239]
    s_add_u32 s5, s4, 139264
    buffer_load_dwordx4 v[104:107], v1, s[28:31], s5 offen offset:0 sc1
    v_add_f32 v197, v197, v205
    v_add_f32 v198, v198, v206
    v_mfma_f32_32x32x16_bf16 v[240:255], a[116:119], v[64:67], v[240:255]
    v_add_f32 v199, v199, v207
    s_waitcnt vmcnt(9)
    v_mfma_f32_32x32x16_bf16 v[224:239], a[120:123], v[68:71], v[224:239]
    buffer_load_dwordx4 v[108:111], v1, s[28:31], s5 offen offset:1024 sc1
    s_waitcnt lgkmcnt(1)
    v_add_f32 v208, v208, v216
    v_mfma_f32_32x32x16_bf16 v[240:255], a[124:127], v[68:71], v[240:255]
    v_add_f32 v209, v209, v217
    v_add_f32 v210, v210, v218
    s_waitcnt vmcnt(9)
    v_mfma_f32_32x32x16_bf16 v[224:239], a[128:131], v[72:75], v[224:239]
    buffer_load_dwordx4 v[112:115], v1, s[28:31], s5 offen offset:2048 sc1
    v_add_f32 v211, v211, v219
    v_mfma_f32_32x32x16_bf16 v[240:255], a[132:135], v[72:75], v[240:255]
    s_waitcnt lgkmcnt(0)
    v_add_f32 v212, v212, v220
    v_add_f32 v213, v213, v221
    s_waitcnt vmcnt(9)
    v_mfma_f32_32x32x16_bf16 v[224:239], a[136:139], v[76:79], v[224:239]
    buffer_load_dwordx4 v[116:119], v1, s[28:31], s5 offen offset:3072 sc1
    v_add_f32 v214, v214, v222
    v_mfma_f32_32x32x16_bf16 v[240:255], a[140:143], v[76:79], v[240:255]
    v_add_f32 v215, v215, v223
    s_waitcnt vmcnt(9)
    v_mfma_f32_32x32x16_bf16 v[224:239], a[144:147], v[80:83], v[224:239]
    v_add_f32 v192, v192, v208
    v_add_f32 v193, v193, v209
    v_mfma_f32_32x32x16_bf16 v[240:255], a[148:151], v[80:83], v[240:255]
    v_add_f32 v194, v194, v210
    s_waitcnt vmcnt(8)
    v_mfma_f32_32x32x16_bf16 v[224:239], a[152:155], v[84:87], v[224:239]
    v_add_f32 v195, v195, v211
    v_add_f32 v196, v196, v212
    v_mfma_f32_32x32x16_bf16 v[240:255], a[156:159], v[84:87], v[240:255]
    v_add_f32 v197, v197, v213
    s_waitcnt vmcnt(7)
    v_mfma_f32_32x32x16_bf16 v[224:239], a[160:163], v[88:91], v[224:239]
    v_add_f32 v198, v198, v214
    v_mfma_f32_32x32x16_bf16 v[240:255], a[164:167], v[88:91], v[240:255]
    v_add_f32 v199, v199, v215
    v_cvt_pk_bf16_f32 v2, v192, v193
    s_waitcnt vmcnt(6)
    v_mfma_f32_32x32x16_bf16 v[224:239], a[168:171], v[92:95], v[224:239]
    v_cvt_pk_bf16_f32 v3, v194, v195
    v_mfma_f32_32x32x16_bf16 v[240:255], a[172:175], v[92:95], v[240:255]
    v_cvt_pk_bf16_f32 v4, v196, v197
    v_cvt_pk_bf16_f32 v5, v198, v199
    s_waitcnt vmcnt(5)
    v_mfma_f32_32x32x16_bf16 v[224:239], a[176:179], v[96:99], v[224:239]
    v_mfma_f32_32x32x16_bf16 v[240:255], a[180:183], v[96:99], v[240:255]
    buffer_store_dwordx4 v[2:5], v20, s[32:35], s54 offen nt
    s_waitcnt vmcnt(5)
    v_mfma_f32_32x32x16_bf16 v[224:239], a[184:187], v[100:103], v[224:239]
    v_mfma_f32_32x32x16_bf16 v[240:255], a[188:191], v[100:103], v[240:255]
    s_waitcnt vmcnt(4)
    v_mfma_f32_32x32x16_bf16 v[224:239], a[192:195], v[104:107], v[224:239]
    v_mfma_f32_32x32x16_bf16 v[240:255], a[196:199], v[104:107], v[240:255]
    s_waitcnt vmcnt(3)
    v_mfma_f32_32x32x16_bf16 v[224:239], a[200:203], v[108:111], v[224:239]
    v_mfma_f32_32x32x16_bf16 v[240:255], a[204:207], v[108:111], v[240:255]
    s_waitcnt vmcnt(2)
    v_mfma_f32_32x32x16_bf16 v[224:239], a[208:211], v[112:115], v[224:239]
    v_mfma_f32_32x32x16_bf16 v[240:255], a[212:215], v[112:115], v[240:255]
    s_waitcnt vmcnt(1)
    v_mfma_f32_32x32x16_bf16 v[224:239], a[216:219], v[116:119], v[224:239]
    v_mfma_f32_32x32x16_bf16 v[240:255], a[220:223], v[116:119], v[240:255]
    s_nop 10
    ds_write_b128 v22, v[224:227] offset:34816
    ds_write_b128 v22, v[228:231] offset:34848
    ds_write_b128 v23, v[232:235] offset:34816
    ds_write_b128 v23, v[236:239] offset:34848
    ds_write_b128 v24, v[240:243] offset:34816
    ds_write_b128 v24, v[244:247] offset:34848
    ds_write_b128 v25, v[248:251] offset:34816
    ds_write_b128 v25, v[252:255] offset:34848
    s_waitcnt lgkmcnt(0)
    s_barrier
    ds_read_b128 v[224:227], v26 offset:34816
    ds_read_b128 v[228:231], v26 offset:34832
    ds_read_b128 v[232:235], v26 offset:43520
    ds_read_b128 v[236:239], v26 offset:43536
    ds_read_b128 v[240:243], v26 offset:52224
    ds_read_b128 v[244:247], v26 offset:52240
    ds_read_b128 v[248:251], v26 offset:60928
    ds_read_b128 v[252:255], v26 offset:60944
    s_waitcnt lgkmcnt(5)
    v_pk_add_f32 v[224:225], v[224:225], v[232:233]
    v_pk_add_f32 v[226:227], v[226:227], v[234:235]
    s_waitcnt lgkmcnt(4)
    v_pk_add_f32 v[228:229], v[228:229], v[236:237]
    v_pk_add_f32 v[230:231], v[230:231], v[238:239]
    s_waitcnt lgkmcnt(1)
    v_pk_add_f32 v[240:241], v[240:241], v[248:249]
    v_pk_add_f32 v[242:243], v[242:243], v[250:251]
    s_waitcnt lgkmcnt(0)
    v_pk_add_f32 v[244:245], v[244:245], v[252:253]
    v_pk_add_f32 v[246:247], v[246:247], v[254:255]
    v_pk_add_f32 v[224:225], v[224:225], v[240:241]
    v_pk_add_f32 v[226:227], v[226:227], v[242:243]
    v_pk_add_f32 v[228:229], v[228:229], v[244:245]
    v_pk_add_f32 v[230:231], v[230:231], v[246:247]
    v_cvt_pk_bf16_f32 v6, v224, v225
    v_cvt_pk_bf16_f32 v7, v226, v227
    v_cvt_pk_bf16_f32 v8, v228, v229
    v_cvt_pk_bf16_f32 v9, v230, v231
    buffer_store_dwordx4 v[6:9], v20, s[32:35], s55 offen nt
L_end:
    s_endpgm
L_code_end:
.section .rodata,"a"
.p2align 6
.amdhsa_kernel sequential_preLN__sliding_block__mixer_channel_mlp__prompt_kernel
  .amdhsa_next_free_vgpr 512
  .amdhsa_next_free_sgpr 102
  .amdhsa_accum_offset 256
  .amdhsa_group_segment_fixed_size 0
  .amdhsa_kernarg_size 88
  .amdhsa_user_sgpr_count 2
  .amdhsa_user_sgpr_kernarg_segment_ptr 1
  .amdhsa_system_sgpr_workgroup_id_x 1
  .amdhsa_float_denorm_mode_32 3
.end_amdhsa_kernel
```
